```python
import torch

def _softmax(x, axis=-1):
    return torch.softmax(x, dim=axis)
def _gelu(x):
    return torch.nn.functional.gelu(x, approximate="tanh")
def _silu(x):
    return torch.nn.functional.silu(x)
def _sigmoid(x):
    return torch.sigmoid(x)
def _layernorm(x, axis=-1, eps=1e-5):
    m = x.mean(dim=axis, keepdim=True)
    v = x.var(dim=axis, keepdim=True, unbiased=False)
    return (x - m) / torch.sqrt(v + eps)
def _scatter_add(tgt, idx, src, axis=0):
    return tgt.clone().index_add_(axis, idx, src)
def _segment_sum(src, seg, n):
    out = torch.zeros((n,) + src.shape[1:], dtype=src.dtype)
    return out.index_add_(0, seg, src)
def _pad(x, pw):
    flat = tuple(v for pair in reversed(pw) for v in pair)
    return torch.nn.functional.pad(x, flat)

kernel_name = 'standalone__glu_gated_swiglu__prompt'

def setup_inputs():

    _w = (lambda a: (lambda t: t.to(torch.bfloat16) if t.is_floating_point() else t)(torch.as_tensor(a)))
    B, S, D, F = 1, 2048, 1024, 3584
    return {
        "x": _w((lambda *s: torch.randn(*s, dtype=torch.bfloat16) * 0.05)(B, S, D)),
        "w1": _w((lambda *s: torch.randn(*s, dtype=torch.bfloat16) * 0.05)(D, F) * (2.0 / D) ** 0.5),
        "w3": _w((lambda *s: torch.randn(*s, dtype=torch.bfloat16) * 0.05)(D, F) * (2.0 / D) ** 0.5),
        "w2": _w((lambda *s: torch.randn(*s, dtype=torch.bfloat16) * 0.05)(F, D) * (2.0 / F) ** 0.5),
    }

def reference(x, w1, w3, w2):
    gate = torch.einsum("bsd,df->bsf", x, w1)
    up = torch.einsum("bsd,df->bsf", x, w3)
    h = _silu(gate) * up
    out = torch.einsum("bsf,fd->bsd", h, w2)
    return out
```

```asm
; @launch grid=(256,1,1) block=(256,1,1) lds=163840
.amdgcn_target "amdgcn-amd-amdhsa--gfx950"
.text
.globl standalone__glu_gated_swiglu__prompt_kernel
.p2align 8
.type standalone__glu_gated_swiglu__prompt_kernel,@function
standalone__glu_gated_swiglu__prompt_kernel:
    s_cmp_ge_u32 s2, 256
    s_cbranch_scc1 L_end
    s_load_dwordx8 s[4:11], s[0:1], 0
    s_load_dwordx4 s[60:63], s[0:1], 32
    s_load_dwordx2 s[16:17], s[0:1], 48
    v_lshrrev_b32 v252, 6, v0
    v_and_b32 v251, 63, v0
    s_and_b32 s3, s2, 7
    v_readfirstlane_b32 s32, v252
    s_lshr_b32 s48, s2, 3
    s_and_b32 s49, s48, 7
    s_lshl_b32 s50, s3, 2
    s_lshr_b32 s51, s48, 3
    s_add_u32 s50, s50, s51
    v_lshrrev_b32 v252, 4, v251
    v_bfe_u32 v253, v251, 1, 3
    v_xor_b32 v253, v253, v252
    v_and_b32 v254, 1, v251
    v_lshlrev_b32 v254, 4, v254
    s_movk_i32 s55, 7168
    v_mad_u32_u24 v254, v252, s55, v254
    s_and_b32 s52, s32, 1
    s_mul_i32 s53, s52, 229376
    s_mul_i32 s54, s50, 224
    s_add_u32 s53, s53, s54
    v_add_u32 v254, s53, v254
    v_mov_b32 v0, 0x40000000
    v_lshl_add_u32 v1, v253, 5, v254
    v_cmp_eq_u32 vcc, 7, v253
    s_nop 1
    v_cndmask_b32 v1, v1, v0, vcc
    v_xor_b32 v253, 4, v253
    v_lshl_add_u32 v2, v253, 5, v254
    v_cmp_eq_u32 vcc, 7, v253
    s_nop 1
    v_cndmask_b32 v2, v2, v0, vcc
    v_add_u32 v224, 0, v1
    v_add_u32 v225, 27648, v1
    v_add_u32 v226, 55296, v2
    v_add_u32 v227, 82944, v2
    v_add_u32 v228, 114688, v1
    v_add_u32 v229, 142336, v1
    v_add_u32 v230, 169984, v2
    v_add_u32 v231, 197632, v2
    v_lshrrev_b32 v252, 3, v251
    v_and_b32 v253, 7, v251
    v_lshrrev_b32 v254, 1, v252
    v_xor_b32 v253, v253, v254
    v_lshlrev_b32 v253, 4, v253
    v_lshl_add_u32 v253, v252, 11, v253
    s_lshl_b32 s51, s49, 2
    s_add_u32 s51, s51, s32
    s_lshl_b32 s53, s51, 17
    v_add_u32 v253, s53, v253
    v_xor_b32 v254, 64, v253
    v_add_u32 v232, 0, v253
    v_add_u32 v233, 15360, v254
    v_add_u32 v234, 30720, v253
    v_add_u32 v235, 46080, v254
    v_add_u32 v236, 65536, v253
    v_add_u32 v237, 80896, v254
    v_add_u32 v238, 96256, v253
    v_add_u32 v239, 111616, v254
    s_lshl_b32 s40, s32, 13
    s_add_u32 s41, s40, 65536
    s_lshl_b32 s57, s48, 1
    s_add_u32 s57, s57, s52
    s_mul_i32 s57, s57, 7168
    s_mul_i32 s58, s3, 896
    s_add_u32 s57, s57, s58
    s_add_u32 s57, s57, 917504
    v_mov_b32 v4, v251
    v_mov_b32 v5, 0
    v_cmp_le_u32 vcc, 14, v4
    v_subrev_u32 v6, 14, v4
    v_add_u32 v7, 458752, v5
    v_cndmask_b32 v4, v4, v6, vcc
    v_cndmask_b32 v5, v5, v7, vcc
    v_cmp_le_u32 vcc, 14, v4
    v_subrev_u32 v6, 14, v4
    v_add_u32 v7, 458752, v5
    v_cndmask_b32 v4, v4, v6, vcc
    v_cndmask_b32 v5, v5, v7, vcc
    v_cmp_le_u32 vcc, 14, v4
    v_subrev_u32 v6, 14, v4
    v_add_u32 v7, 458752, v5
    v_cndmask_b32 v4, v4, v6, vcc
    v_cndmask_b32 v5, v5, v7, vcc
    v_lshl_add_u32 v4, v4, 6, v5
    v_add_u32 v4, s57, v4
    v_cmp_gt_u32 vcc, 28, v251
    s_nop 1
    v_cndmask_b32 v4, v0, v4, vcc
    s_waitcnt lgkmcnt(0)
    s_cmp_ge_u32 s32, 2
    s_cselect_b32 s24, s8, s6
    s_cselect_b32 s25, s9, s7
    s_and_b32 s25, s25, 0xffff
    s_mov_b32 s26, 7340032
    s_mov_b32 s27, 0x00020000
    s_mov_b32 s20, s4
    s_and_b32 s21, s5, 0xffff
    s_mov_b32 s22, 4194304
    s_mov_b32 s23, 0x00020000
    s_mov_b32 s57, 0
    buffer_load_dword a152, v4, s[24:27], s57 offen
    s_mov_b32 s34, 0
    s_add_u32 m0, s41, 0
    s_nop 0
    buffer_load_dwordx4 v224, s[24:27], s34 offen offset:0 nt lds
    buffer_load_dwordx4 v225, s[24:27], s34 offen offset:1024 nt lds
    buffer_load_dwordx4 v226, s[24:27], s34 offen offset:2048 nt lds
    buffer_load_dwordx4 v227, s[24:27], s34 offen offset:3072 nt lds
    s_add_u32 m0, s41, 4096
    s_nop 0
    buffer_load_dwordx4 v228, s[24:27], s34 offen offset:0 nt lds
    buffer_load_dwordx4 v229, s[24:27], s34 offen offset:1024 nt lds
    buffer_load_dwordx4 v230, s[24:27], s34 offen offset:2048 nt lds
    buffer_load_dwordx4 v231, s[24:27], s34 offen offset:3072 nt lds
    s_mov_b32 s33, 0
    s_add_u32 m0, s40, 0
    s_nop 0
    buffer_load_dwordx4 v232, s[20:23], s33 offen offset:0 lds
    buffer_load_dwordx4 v233, s[20:23], s33 offen offset:1024 lds
    buffer_load_dwordx4 v234, s[20:23], s33 offen offset:2048 lds
    buffer_load_dwordx4 v235, s[20:23], s33 offen offset:3072 lds
    s_add_u32 m0, s40, 4096
    s_nop 0
    buffer_load_dwordx4 v236, s[20:23], s33 offen offset:0 lds
    buffer_load_dwordx4 v237, s[20:23], s33 offen offset:1024 lds
    buffer_load_dwordx4 v238, s[20:23], s33 offen offset:2048 lds
    buffer_load_dwordx4 v239, s[20:23], s33 offen offset:3072 lds
    v_and_b32 v252, 15, v251
    v_lshrrev_b32 v253, 4, v251
    v_bfe_u32 v254, v251, 1, 3
    v_xor_b32 v254, v254, v253
    v_lshlrev_b32 v254, 4, v254
    v_lshl_add_u32 v254, v252, 7, v254
    v_add_u32 v247, s40, v254
    v_xor_b32 v248, 64, v247
    v_bfe_u32 v252, v251, 2, 3
    v_bfe_u32 v254, v251, 2, 2
    v_lshl_add_u32 v254, v253, 3, v254
    v_lshlrev_b32 v254, 8, v254
    v_and_b32 v255, 3, v251
    v_lshl_add_u32 v254, v255, 3, v254
    v_add_u32 v254, 65536, v254
    v_xor_b32 v255, 0, v252
    v_lshl_add_u32 v240, v255, 5, v254
    v_xor_b32 v255, 1, v252
    v_lshl_add_u32 v241, v255, 5, v254
    v_xor_b32 v255, 2, v252
    v_lshl_add_u32 v242, v255, 5, v254
    v_xor_b32 v255, 3, v252
    v_lshl_add_u32 v243, v255, 5, v254
    v_xor_b32 v255, 4, v252
    v_lshl_add_u32 v244, v255, 5, v254
    v_xor_b32 v255, 5, v252
    v_lshl_add_u32 v245, v255, 5, v254
    v_xor_b32 v255, 6, v252
    v_lshl_add_u32 v246, v255, 5, v254
    s_mov_b32 s12, s10
    s_and_b32 s13, s11, 0xffff
    s_mov_b32 s14, 7340032
    s_mov_b32 s15, 0x00020000
    s_lshl_b32 s56, s2, 2
    s_add_u32 s56, s56, s32
    s_lshl_b32 s57, s48, 2
    s_add_u32 s57, s57, s32
    s_lshl_b32 s57, s57, 15
    v_lshrrev_b32 v252, 1, v251
    v_lshlrev_b32 v252, 11, v252
    v_and_b32 v253, 1, v251
    v_lshl_add_u32 v252, v253, 6, v252
    v_add_u32 v252, s57, v252
    v_cmp_gt_u32 vcc, 32, v251
    s_lshl_b32 s57, s48, 1
    s_add_u32 s57, s57, s52
    v_cndmask_b32 v249, v0, v252, vcc
    s_mul_i32 s57, s57, 7168
    s_mul_i32 s58, s3, 896
    s_add_u32 s57, s57, s58
    v_lshlrev_b32 v253, 6, v251
    v_add_u32 v252, s57, v253
    v_cmp_gt_u32 vcc, 14, v251
    s_mul_i32 s57, s56, 512
    s_mov_b32 s43, 0
    v_cndmask_b32 v255, v0, v252, vcc
    v_add_u32 v252, s57, v253
    v_cmp_gt_u32 vcc, 8, v251
    s_mov_b32 s28, s16
    s_and_b32 s29, s17, 0xffff
    v_cndmask_b32 v250, v0, v252, vcc
    s_mov_b32 s30, 58720256
    s_mov_b32 s31, 0x00020000
    s_mov_b32 s44, 0xbfb8aa3b
    s_mov_b32 s45, 0xbfb8aa3b
    s_mov_b32 s18, 1.0
    s_mov_b32 s19, 1.0
    s_mov_b32 s52, s62
    s_and_b32 s53, s63, 0xffff
    s_mov_b32 s54, 4
    s_mov_b32 s55, 0x00020000
    v_accvgpr_write_b32 a140, 0
    v_accvgpr_write_b32 a141, 0
    v_accvgpr_write_b32 a142, 0
    v_accvgpr_write_b32 a143, 0
    v_lshlrev_b32 v253, 2, v251
    v_lshlrev_b32 v254, 4, v251
    s_lshl_b32 s62, s56, 13
    s_add_u32 s62, s62, 50331648
    v_mfma_f32_32x32x16_bf16 v[0:15], a[140:143], a[140:143], 0
    v_mfma_f32_32x32x16_bf16 v[16:31], a[140:143], a[140:143], 0
    v_mfma_f32_32x32x16_bf16 v[32:47], a[140:143], a[140:143], 0
    v_mfma_f32_32x32x16_bf16 v[48:63], a[140:143], a[140:143], 0
    v_mfma_f32_32x32x16_bf16 v[64:79], a[140:143], a[140:143], 0
    v_mfma_f32_32x32x16_bf16 v[80:95], a[140:143], a[140:143], 0
    v_mfma_f32_32x32x16_bf16 v[96:111], a[140:143], a[140:143], 0
    v_mfma_f32_32x32x16_bf16 v[112:127], a[140:143], a[140:143], 0
    v_mfma_f32_32x32x16_bf16 v[128:143], a[140:143], a[140:143], 0
    v_mfma_f32_32x32x16_bf16 v[144:159], a[140:143], a[140:143], 0
    v_mfma_f32_32x32x16_bf16 v[160:175], a[140:143], a[140:143], 0
    v_mfma_f32_32x32x16_bf16 v[176:191], a[140:143], a[140:143], 0
    v_mfma_f32_32x32x16_bf16 v[192:207], a[140:143], a[140:143], 0
    v_mfma_f32_32x32x16_bf16 v[208:223], a[140:143], a[140:143], 0
    s_mov_b32 s34, 458752
    s_add_u32 m0, s41, 32768
    s_nop 0
    buffer_load_dwordx4 v224, s[24:27], s34 offen offset:0 nt lds
    buffer_load_dwordx4 v225, s[24:27], s34 offen offset:1024 nt lds
    buffer_load_dwordx4 v226, s[24:27], s34 offen offset:2048 nt lds
    buffer_load_dwordx4 v227, s[24:27], s34 offen offset:3072 nt lds
    s_add_u32 m0, s41, 36864
    s_nop 0
    buffer_load_dwordx4 v228, s[24:27], s34 offen offset:0 nt lds
    buffer_load_dwordx4 v229, s[24:27], s34 offen offset:1024 nt lds
    buffer_load_dwordx4 v230, s[24:27], s34 offen offset:2048 nt lds
    buffer_load_dwordx4 v231, s[24:27], s34 offen offset:3072 nt lds
    s_getpc_b64 s[6:7]
L_pca:
    s_lshl_b32 s8, s48, 2
    s_add_u32 s8, s8, s32
    s_lshl_b32 s8, s8, 6
    s_add_u32 s8, s8, L1_loop - L_pca
    s_add_u32 s6, s6, s8
    s_addc_u32 s7, s7, 0
    s_load_dword s8, s[6:7], 0
    s_load_dword s8, s[6:7], 8192
    s_load_dword s8, s[6:7], 16384
    s_cmp_lg_u32 s56, 0
    s_cbranch_scc1 L_notok
    s_memrealtime s[4:5]
    s_waitcnt lgkmcnt(0)
    s_or_b32 s4, s4, 1
    v_mov_b32 v252, s4
    buffer_store_dword v252, v253, s[52:55], 0 offen sc1
L_notok:
    s_mov_b32 s34, 917504
    s_mov_b32 s33, 128
    s_mov_b32 s42, 458752
    s_mov_b32 s59, 128
    s_mov_b32 s57, 512
    s_mov_b32 s58, 1835008
    s_mov_b32 s35, s40
    s_add_u32 s36, s41, 65536
    s_mov_b32 s47, 0
    s_mov_b32 s46, 32768
    s_mov_b32 s38, 0
    s_waitcnt vmcnt(8)
    s_barrier
    ds_read_b128 a[112:115], v247 offset:0
    ds_read_b128 a[116:119], v247 offset:2048
    ds_read_b128 a[120:123], v247 offset:4096
    ds_read_b128 a[124:127], v247 offset:6144
    ds_read_b64_tr_b16 a[0:1], v240 offset:0
    ds_read_b64_tr_b16 a[2:3], v240 offset:1024
    ds_read_b64_tr_b16 a[4:5], v240 offset:16384
    ds_read_b64_tr_b16 a[6:7], v240 offset:17408
    ds_read_b64_tr_b16 a[8:9], v241 offset:0
    ds_read_b64_tr_b16 a[10:11], v241 offset:1024
    ds_read_b64_tr_b16 a[12:13], v241 offset:16384
    ds_read_b64_tr_b16 a[14:15], v241 offset:17408
    ds_read_b64_tr_b16 a[16:17], v242 offset:0
    ds_read_b64_tr_b16 a[18:19], v242 offset:1024
    ds_read_b64_tr_b16 a[20:21], v242 offset:16384
    ds_read_b64_tr_b16 a[22:23], v242 offset:17408
    ds_read_b64_tr_b16 a[24:25], v243 offset:0
    ds_read_b64_tr_b16 a[26:27], v243 offset:1024
    ds_read_b64_tr_b16 a[28:29], v243 offset:16384
    ds_read_b64_tr_b16 a[30:31], v243 offset:17408
    ds_read_b64_tr_b16 a[32:33], v244 offset:0
    ds_read_b64_tr_b16 a[34:35], v244 offset:1024
    ds_read_b64_tr_b16 a[36:37], v244 offset:16384
    ds_read_b64_tr_b16 a[38:39], v244 offset:17408
    ds_read_b64_tr_b16 a[40:41], v245 offset:0
    ds_read_b64_tr_b16 a[42:43], v245 offset:1024
    ds_read_b64_tr_b16 a[44:45], v245 offset:16384
    ds_read_b64_tr_b16 a[46:47], v245 offset:17408
    ds_read_b64_tr_b16 a[48:49], v246 offset:0
    ds_read_b64_tr_b16 a[50:51], v246 offset:1024
    ds_read_b64_tr_b16 a[52:53], v246 offset:16384
    ds_read_b64_tr_b16 a[54:55], v246 offset:17408
    s_add_u32 m0, s40, 32768
    s_nop 0
    buffer_load_dwordx4 v232, s[20:23], s33 offen offset:0 lds
    buffer_load_dwordx4 v233, s[20:23], s33 offen offset:1024 lds
    buffer_load_dwordx4 v234, s[20:23], s33 offen offset:2048 lds
    buffer_load_dwordx4 v235, s[20:23], s33 offen offset:3072 lds
    s_add_u32 m0, s40, 36864
    s_waitcnt lgkmcnt(0)
    v_mfma_f32_16x16x32_bf16 v[0:3], a[0:3], a[112:115], v[0:3]
    ds_read_b128 a[128:131], v248 offset:0
    buffer_load_dwordx4 v236, s[20:23], s33 offen offset:0 lds
    v_mfma_f32_16x16x32_bf16 v[4:7], a[0:3], a[116:119], v[4:7]
    ds_read_b128 a[132:135], v248 offset:2048
    v_mfma_f32_16x16x32_bf16 v[8:11], a[0:3], a[120:123], v[8:11]
    ds_read_b128 a[136:139], v248 offset:4096
    buffer_load_dwordx4 v237, s[20:23], s33 offen offset:1024 lds
    v_mfma_f32_16x16x32_bf16 v[12:15], a[0:3], a[124:127], v[12:15]
    v_mfma_f32_16x16x32_bf16 v[16:19], a[4:7], a[112:115], v[16:19]
    ds_read_b128 a[140:143], v248 offset:6144
    buffer_load_dwordx4 v238, s[20:23], s33 offen offset:2048 lds
    v_mfma_f32_16x16x32_bf16 v[20:23], a[4:7], a[116:119], v[20:23]
    ds_read_b64_tr_b16 a[56:57], v240 offset:8192
    v_mfma_f32_16x16x32_bf16 v[24:27], a[4:7], a[120:123], v[24:27]
    ds_read_b64_tr_b16 a[58:59], v240 offset:9216
    buffer_load_dwordx4 v239, s[20:23], s33 offen offset:3072 lds
    s_mov_b32 s33, 256
    v_mfma_f32_16x16x32_bf16 v[28:31], a[4:7], a[124:127], v[28:31]
    v_mfma_f32_16x16x32_bf16 v[32:35], a[8:11], a[112:115], v[32:35]
    ds_read_b64_tr_b16 a[60:61], v240 offset:24576
    s_mov_b32 m0, s36
    v_mfma_f32_16x16x32_bf16 v[36:39], a[8:11], a[116:119], v[36:39]
    ds_read_b64_tr_b16 a[62:63], v240 offset:25600
    buffer_load_dwordx4 v224, s[24:27], s34 offen offset:0 nt lds
    v_mfma_f32_16x16x32_bf16 v[40:43], a[8:11], a[120:123], v[40:43]
    ds_read_b64_tr_b16 a[64:65], v241 offset:8192
    v_mfma_f32_16x16x32_bf16 v[44:47], a[8:11], a[124:127], v[44:47]
    buffer_load_dwordx4 v225, s[24:27], s34 offen offset:1024 nt lds
    v_mfma_f32_16x16x32_bf16 v[48:51], a[12:15], a[112:115], v[48:51]
    ds_read_b64_tr_b16 a[66:67], v241 offset:9216
    v_mfma_f32_16x16x32_bf16 v[52:55], a[12:15], a[116:119], v[52:55]
    ds_read_b64_tr_b16 a[68:69], v241 offset:24576
    buffer_load_dwordx4 v226, s[24:27], s34 offen offset:2048 nt lds
    v_mfma_f32_16x16x32_bf16 v[56:59], a[12:15], a[120:123], v[56:59]
    ds_read_b64_tr_b16 a[70:71], v241 offset:25600
    v_mfma_f32_16x16x32_bf16 v[60:63], a[12:15], a[124:127], v[60:63]
    buffer_load_dwordx4 v227, s[24:27], s34 offen offset:3072 nt lds
    v_mfma_f32_16x16x32_bf16 v[64:67], a[16:19], a[112:115], v[64:67]
    ds_read_b64_tr_b16 a[72:73], v242 offset:8192
    v_mfma_f32_16x16x32_bf16 v[68:71], a[16:19], a[116:119], v[68:71]
    ds_read_b64_tr_b16 a[74:75], v242 offset:9216
    s_add_u32 m0, s36, 4096
    v_mfma_f32_16x16x32_bf16 v[72:75], a[16:19], a[120:123], v[72:75]
    ds_read_b64_tr_b16 a[76:77], v242 offset:24576
    buffer_load_dwordx4 v228, s[24:27], s34 offen offset:0 nt lds
    v_mfma_f32_16x16x32_bf16 v[76:79], a[16:19], a[124:127], v[76:79]
    v_mfma_f32_16x16x32_bf16 v[80:83], a[20:23], a[112:115], v[80:83]
    ds_read_b64_tr_b16 a[78:79], v242 offset:25600
    buffer_load_dwordx4 v229, s[24:27], s34 offen offset:1024 nt lds
    v_mfma_f32_16x16x32_bf16 v[84:87], a[20:23], a[116:119], v[84:87]
    ds_read_b64_tr_b16 a[80:81], v243 offset:8192
    v_mfma_f32_16x16x32_bf16 v[88:91], a[20:23], a[120:123], v[88:91]
    ds_read_b64_tr_b16 a[82:83], v243 offset:9216
    buffer_load_dwordx4 v230, s[24:27], s34 offen offset:2048 nt lds
    v_mfma_f32_16x16x32_bf16 v[92:95], a[20:23], a[124:127], v[92:95]
    v_mfma_f32_16x16x32_bf16 v[96:99], a[24:27], a[112:115], v[96:99]
    ds_read_b64_tr_b16 a[84:85], v243 offset:24576
    buffer_load_dwordx4 v231, s[24:27], s34 offen offset:3072 nt lds
    v_mfma_f32_16x16x32_bf16 v[100:103], a[24:27], a[116:119], v[100:103]
    ds_read_b64_tr_b16 a[86:87], v243 offset:25600
    s_add_u32 s34, s34, s42
    s_lshl_b32 s39, s47, 15
    v_mfma_f32_16x16x32_bf16 v[104:107], a[24:27], a[120:123], v[104:107]
    ds_read_b64_tr_b16 a[88:89], v244 offset:8192
    s_waitcnt lgkmcnt(8)
    s_add_u32 s36, s41, s39
    s_add_u32 s47, s47, 1
    v_mfma_f32_16x16x32_bf16 v[108:111], a[24:27], a[124:127], v[108:111]
    s_mov_b32 m0, s35
    s_cmp_eq_u32 s47, 3
    s_cselect_b32 s37, 4294901760, s46
    s_cselect_b32 s47, 0, s47
    v_mfma_f32_16x16x32_bf16 v[112:115], a[28:31], a[112:115], v[112:115]
    ds_read_b64_tr_b16 a[90:91], v244 offset:9216
    buffer_load_dwordx4 v232, s[20:23], s33 offen offset:0 lds
    v_mfma_f32_16x16x32_bf16 v[116:119], a[28:31], a[116:119], v[116:119]
    ds_read_b64_tr_b16 a[92:93], v244 offset:24576
    v_mfma_f32_16x16x32_bf16 v[120:123], a[28:31], a[120:123], v[120:123]
    ds_read_b64_tr_b16 a[94:95], v244 offset:25600
    buffer_load_dwordx4 v233, s[20:23], s33 offen offset:1024 lds
    v_mfma_f32_16x16x32_bf16 v[124:127], a[28:31], a[124:127], v[124:127]
    v_mfma_f32_16x16x32_bf16 v[128:131], a[32:35], a[112:115], v[128:131]
    ds_read_b64_tr_b16 a[96:97], v245 offset:8192
    buffer_load_dwordx4 v234, s[20:23], s33 offen offset:2048 lds
    v_mfma_f32_16x16x32_bf16 v[132:135], a[32:35], a[116:119], v[132:135]
    ds_read_b64_tr_b16 a[98:99], v245 offset:9216
    v_mfma_f32_16x16x32_bf16 v[136:139], a[32:35], a[120:123], v[136:139]
    ds_read_b64_tr_b16 a[100:101], v245 offset:24576
    buffer_load_dwordx4 v235, s[20:23], s33 offen offset:3072 lds
    v_mfma_f32_16x16x32_bf16 v[140:143], a[32:35], a[124:127], v[140:143]
    v_mfma_f32_16x16x32_bf16 v[144:147], a[36:39], a[112:115], v[144:147]
    ds_read_b64_tr_b16 a[102:103], v245 offset:25600
    s_add_u32 m0, s35, 4096
    v_mfma_f32_16x16x32_bf16 v[148:151], a[36:39], a[116:119], v[148:151]
    ds_read_b64_tr_b16 a[104:105], v246 offset:8192
    buffer_load_dwordx4 v236, s[20:23], s33 offen offset:0 lds
    v_mfma_f32_16x16x32_bf16 v[152:155], a[36:39], a[120:123], v[152:155]
    ds_read_b64_tr_b16 a[106:107], v246 offset:9216
    v_mfma_f32_16x16x32_bf16 v[156:159], a[36:39], a[124:127], v[156:159]
    v_mfma_f32_16x16x32_bf16 v[160:163], a[40:43], a[112:115], v[160:163]
    ds_read_b64_tr_b16 a[108:109], v246 offset:24576
    buffer_load_dwordx4 v237, s[20:23], s33 offen offset:1024 lds
    v_mfma_f32_16x16x32_bf16 v[164:167], a[40:43], a[116:119], v[164:167]
    ds_read_b64_tr_b16 a[110:111], v246 offset:25600
    v_mfma_f32_16x16x32_bf16 v[168:171], a[40:43], a[120:123], v[168:171]
    v_add_u32 v240, s37, v240
    v_mfma_f32_16x16x32_bf16 v[172:175], a[40:43], a[124:127], v[172:175]
    buffer_load_dwordx4 v238, s[20:23], s33 offen offset:2048 lds
    v_add_u32 v241, s37, v241
    v_mfma_f32_16x16x32_bf16 v[176:179], a[44:47], a[112:115], v[176:179]
    v_add_u32 v242, s37, v242
    v_mfma_f32_16x16x32_bf16 v[180:183], a[44:47], a[116:119], v[180:183]
    v_add_u32 v243, s37, v243
    v_mfma_f32_16x16x32_bf16 v[184:187], a[44:47], a[120:123], v[184:187]
    buffer_load_dwordx4 v239, s[20:23], s33 offen offset:3072 lds
    v_add_u32 v244, s37, v244
    v_mfma_f32_16x16x32_bf16 v[188:191], a[44:47], a[124:127], v[188:191]
    v_add_u32 v245, s37, v245
    s_xor_b32 s35, s35, 0x8000
    s_add_u32 s33, s33, s59
    v_mfma_f32_16x16x32_bf16 v[192:195], a[48:51], a[112:115], v[192:195]
    v_add_u32 v246, s37, v246
    v_mfma_f32_16x16x32_bf16 v[196:199], a[48:51], a[116:119], v[196:199]
    buffer_load_dword a144, v255, s[24:27], s58 offen
    v_xor_b32 v247, 0x8000, v247
    v_mfma_f32_16x16x32_bf16 v[200:203], a[48:51], a[120:123], v[200:203]
    v_xor_b32 v248, 0x8000, v248
    v_mfma_f32_16x16x32_bf16 v[204:207], a[48:51], a[124:127], v[204:207]
    buffer_load_dword a144, v249, s[20:23], s57 offen
    v_mfma_f32_16x16x32_bf16 v[208:211], a[52:55], a[112:115], v[208:211]
    v_mfma_f32_16x16x32_bf16 v[212:215], a[52:55], a[116:119], v[212:215]
    buffer_load_dword a144, v250, s[12:15], s43 offen
    v_mfma_f32_16x16x32_bf16 v[216:219], a[52:55], a[120:123], v[216:219]
    s_add_u32 s58, s58, 458752
    s_add_u32 s43, s43, 524288
    s_add_u32 s57, s57, 128
    v_mfma_f32_16x16x32_bf16 v[220:223], a[52:55], a[124:127], v[220:223]
    s_min_u32 s57, s57, 1920
    s_min_u32 s58, s58, 6881280
    s_add_u32 s38, s38, 1
    s_cmp_lt_u32 s38, 14
    s_waitcnt vmcnt(19) lgkmcnt(0)
    s_branch L1_bar
.p2align 6
L1_loop:
    s_waitcnt vmcnt(22) lgkmcnt(0)
L1_bar:
    s_barrier
    v_mfma_f32_16x16x32_bf16 v[0:3], a[56:59], a[128:131], v[0:3]
    ds_read_b128 a[112:115], v247 offset:0
    v_mfma_f32_16x16x32_bf16 v[4:7], a[56:59], a[132:135], v[4:7]
    ds_read_b128 a[116:119], v247 offset:2048
    v_mfma_f32_16x16x32_bf16 v[8:11], a[56:59], a[136:139], v[8:11]
    ds_read_b128 a[120:123], v247 offset:4096
    s_mov_b32 m0, s36
    v_mfma_f32_16x16x32_bf16 v[12:15], a[56:59], a[140:143], v[12:15]
    buffer_load_dwordx4 v224, s[24:27], s34 offen offset:0 nt lds
    v_mfma_f32_16x16x32_bf16 v[16:19], a[60:63], a[128:131], v[16:19]
    ds_read_b128 a[124:127], v247 offset:6144
    v_mfma_f32_16x16x32_bf16 v[20:23], a[60:63], a[132:135], v[20:23]
    ds_read_b64_tr_b16 a[0:1], v240 offset:0
    v_mfma_f32_16x16x32_bf16 v[24:27], a[60:63], a[136:139], v[24:27]
    ds_read_b64_tr_b16 a[2:3], v240 offset:1024
    v_mfma_f32_16x16x32_bf16 v[28:31], a[60:63], a[140:143], v[28:31]
    v_mfma_f32_16x16x32_bf16 v[32:35], a[64:67], a[128:131], v[32:35]
    ds_read_b64_tr_b16 a[4:5], v240 offset:16384
    v_mfma_f32_16x16x32_bf16 v[36:39], a[64:67], a[132:135], v[36:39]
    ds_read_b64_tr_b16 a[6:7], v240 offset:17408
    v_mfma_f32_16x16x32_bf16 v[40:43], a[64:67], a[136:139], v[40:43]
    ds_read_b64_tr_b16 a[8:9], v241 offset:0
    v_mfma_f32_16x16x32_bf16 v[44:47], a[64:67], a[140:143], v[44:47]
    buffer_load_dwordx4 v225, s[24:27], s34 offen offset:1024 nt lds
    v_mfma_f32_16x16x32_bf16 v[48:51], a[68:71], a[128:131], v[48:51]
    ds_read_b64_tr_b16 a[10:11], v241 offset:1024
    v_mfma_f32_16x16x32_bf16 v[52:55], a[68:71], a[132:135], v[52:55]
    ds_read_b64_tr_b16 a[12:13], v241 offset:16384
    v_mfma_f32_16x16x32_bf16 v[56:59], a[68:71], a[136:139], v[56:59]
    ds_read_b64_tr_b16 a[14:15], v241 offset:17408
    v_mfma_f32_16x16x32_bf16 v[60:63], a[68:71], a[140:143], v[60:63]
    v_mfma_f32_16x16x32_bf16 v[64:67], a[72:75], a[128:131], v[64:67]
    ds_read_b64_tr_b16 a[16:17], v242 offset:0
    v_mfma_f32_16x16x32_bf16 v[68:71], a[72:75], a[132:135], v[68:71]
    ds_read_b64_tr_b16 a[18:19], v242 offset:1024
    v_mfma_f32_16x16x32_bf16 v[72:75], a[72:75], a[136:139], v[72:75]
    ds_read_b64_tr_b16 a[20:21], v242 offset:16384
    v_mfma_f32_16x16x32_bf16 v[76:79], a[72:75], a[140:143], v[76:79]
    buffer_load_dwordx4 v226, s[24:27], s34 offen offset:2048 nt lds
    v_mfma_f32_16x16x32_bf16 v[80:83], a[76:79], a[128:131], v[80:83]
    ds_read_b64_tr_b16 a[22:23], v242 offset:17408
    v_mfma_f32_16x16x32_bf16 v[84:87], a[76:79], a[132:135], v[84:87]
    ds_read_b64_tr_b16 a[24:25], v243 offset:0
    v_mfma_f32_16x16x32_bf16 v[88:91], a[76:79], a[136:139], v[88:91]
    ds_read_b64_tr_b16 a[26:27], v243 offset:1024
    v_mfma_f32_16x16x32_bf16 v[92:95], a[76:79], a[140:143], v[92:95]
    v_mfma_f32_16x16x32_bf16 v[96:99], a[80:83], a[128:131], v[96:99]
    ds_read_b64_tr_b16 a[28:29], v243 offset:16384
    v_mfma_f32_16x16x32_bf16 v[100:103], a[80:83], a[132:135], v[100:103]
    ds_read_b64_tr_b16 a[30:31], v243 offset:17408
    v_mfma_f32_16x16x32_bf16 v[104:107], a[80:83], a[136:139], v[104:107]
    ds_read_b64_tr_b16 a[32:33], v244 offset:0
    v_mfma_f32_16x16x32_bf16 v[108:111], a[80:83], a[140:143], v[108:111]
    buffer_load_dwordx4 v227, s[24:27], s34 offen offset:3072 nt lds
    v_mfma_f32_16x16x32_bf16 v[112:115], a[84:87], a[128:131], v[112:115]
    ds_read_b64_tr_b16 a[34:35], v244 offset:1024
    v_mfma_f32_16x16x32_bf16 v[116:119], a[84:87], a[132:135], v[116:119]
    ds_read_b64_tr_b16 a[36:37], v244 offset:16384
    v_mfma_f32_16x16x32_bf16 v[120:123], a[84:87], a[136:139], v[120:123]
    ds_read_b64_tr_b16 a[38:39], v244 offset:17408
    v_mfma_f32_16x16x32_bf16 v[124:127], a[84:87], a[140:143], v[124:127]
    v_mfma_f32_16x16x32_bf16 v[128:131], a[88:91], a[128:131], v[128:131]
    ds_read_b64_tr_b16 a[40:41], v245 offset:0
    v_mfma_f32_16x16x32_bf16 v[132:135], a[88:91], a[132:135], v[132:135]
    ds_read_b64_tr_b16 a[42:43], v245 offset:1024
    v_mfma_f32_16x16x32_bf16 v[136:139], a[88:91], a[136:139], v[136:139]
    ds_read_b64_tr_b16 a[44:45], v245 offset:16384
    s_add_u32 m0, s36, 4096
    v_mfma_f32_16x16x32_bf16 v[140:143], a[88:91], a[140:143], v[140:143]
    buffer_load_dwordx4 v228, s[24:27], s34 offen offset:0 nt lds
    v_mfma_f32_16x16x32_bf16 v[144:147], a[92:95], a[128:131], v[144:147]
    ds_read_b64_tr_b16 a[46:47], v245 offset:17408
    v_mfma_f32_16x16x32_bf16 v[148:151], a[92:95], a[132:135], v[148:151]
    ds_read_b64_tr_b16 a[48:49], v246 offset:0
    v_mfma_f32_16x16x32_bf16 v[152:155], a[92:95], a[136:139], v[152:155]
    ds_read_b64_tr_b16 a[50:51], v246 offset:1024
    v_mfma_f32_16x16x32_bf16 v[156:159], a[92:95], a[140:143], v[156:159]
    v_mfma_f32_16x16x32_bf16 v[160:163], a[96:99], a[128:131], v[160:163]
    ds_read_b64_tr_b16 a[52:53], v246 offset:16384
    v_mfma_f32_16x16x32_bf16 v[164:167], a[96:99], a[132:135], v[164:167]
    ds_read_b64_tr_b16 a[54:55], v246 offset:17408
    v_mfma_f32_16x16x32_bf16 v[168:171], a[96:99], a[136:139], v[168:171]
    v_mfma_f32_16x16x32_bf16 v[172:175], a[96:99], a[140:143], v[172:175]
    buffer_load_dwordx4 v229, s[24:27], s34 offen offset:1024 nt lds
    v_mfma_f32_16x16x32_bf16 v[176:179], a[100:103], a[128:131], v[176:179]
    v_mfma_f32_16x16x32_bf16 v[180:183], a[100:103], a[132:135], v[180:183]
    v_mfma_f32_16x16x32_bf16 v[184:187], a[100:103], a[136:139], v[184:187]
    v_mfma_f32_16x16x32_bf16 v[188:191], a[100:103], a[140:143], v[188:191]
    v_mfma_f32_16x16x32_bf16 v[192:195], a[104:107], a[128:131], v[192:195]
    v_mfma_f32_16x16x32_bf16 v[196:199], a[104:107], a[132:135], v[196:199]
    v_mfma_f32_16x16x32_bf16 v[200:203], a[104:107], a[136:139], v[200:203]
    v_mfma_f32_16x16x32_bf16 v[204:207], a[104:107], a[140:143], v[204:207]
    v_mfma_f32_16x16x32_bf16 v[208:211], a[108:111], a[128:131], v[208:211]
    v_mfma_f32_16x16x32_bf16 v[212:215], a[108:111], a[132:135], v[212:215]
    v_mfma_f32_16x16x32_bf16 v[216:219], a[108:111], a[136:139], v[216:219]
    v_mfma_f32_16x16x32_bf16 v[220:223], a[108:111], a[140:143], v[220:223]
    s_waitcnt lgkmcnt(0)
    v_mfma_f32_16x16x32_bf16 v[0:3], a[0:3], a[112:115], v[0:3]
    ds_read_b128 a[128:131], v248 offset:0
    v_mfma_f32_16x16x32_bf16 v[4:7], a[0:3], a[116:119], v[4:7]
    ds_read_b128 a[132:135], v248 offset:2048
    v_mfma_f32_16x16x32_bf16 v[8:11], a[0:3], a[120:123], v[8:11]
    ds_read_b128 a[136:139], v248 offset:4096
    v_mfma_f32_16x16x32_bf16 v[12:15], a[0:3], a[124:127], v[12:15]
    buffer_load_dwordx4 v230, s[24:27], s34 offen offset:2048 nt lds
    v_mfma_f32_16x16x32_bf16 v[16:19], a[4:7], a[112:115], v[16:19]
    ds_read_b128 a[140:143], v248 offset:6144
    v_mfma_f32_16x16x32_bf16 v[20:23], a[4:7], a[116:119], v[20:23]
    ds_read_b64_tr_b16 a[56:57], v240 offset:8192
    v_mfma_f32_16x16x32_bf16 v[24:27], a[4:7], a[120:123], v[24:27]
    ds_read_b64_tr_b16 a[58:59], v240 offset:9216
    v_mfma_f32_16x16x32_bf16 v[28:31], a[4:7], a[124:127], v[28:31]
    buffer_load_dwordx4 v231, s[24:27], s34 offen offset:3072 nt lds
    v_mfma_f32_16x16x32_bf16 v[32:35], a[8:11], a[112:115], v[32:35]
    ds_read_b64_tr_b16 a[60:61], v240 offset:24576
    s_add_u32 s34, s34, s42
    s_lshl_b32 s39, s47, 15
    v_mfma_f32_16x16x32_bf16 v[36:39], a[8:11], a[116:119], v[36:39]
    ds_read_b64_tr_b16 a[62:63], v240 offset:25600
    s_add_u32 s36, s41, s39
    s_add_u32 s47, s47, 1
    v_mfma_f32_16x16x32_bf16 v[40:43], a[8:11], a[120:123], v[40:43]
    ds_read_b64_tr_b16 a[64:65], v241 offset:8192
    s_cmp_eq_u32 s47, 3
    s_cselect_b32 s37, 4294901760, s46
    s_cselect_b32 s47, 0, s47
    v_mfma_f32_16x16x32_bf16 v[44:47], a[8:11], a[124:127], v[44:47]
    v_mfma_f32_16x16x32_bf16 v[48:51], a[12:15], a[112:115], v[48:51]
    ds_read_b64_tr_b16 a[66:67], v241 offset:9216
    v_mfma_f32_16x16x32_bf16 v[52:55], a[12:15], a[116:119], v[52:55]
    ds_read_b64_tr_b16 a[68:69], v241 offset:24576
    v_mfma_f32_16x16x32_bf16 v[56:59], a[12:15], a[120:123], v[56:59]
    ds_read_b64_tr_b16 a[70:71], v241 offset:25600
    v_mfma_f32_16x16x32_bf16 v[60:63], a[12:15], a[124:127], v[60:63]
    v_mfma_f32_16x16x32_bf16 v[64:67], a[16:19], a[112:115], v[64:67]
    ds_read_b64_tr_b16 a[72:73], v242 offset:8192
    v_mfma_f32_16x16x32_bf16 v[68:71], a[16:19], a[116:119], v[68:71]
    ds_read_b64_tr_b16 a[74:75], v242 offset:9216
    s_waitcnt lgkmcnt(8)
    v_mfma_f32_16x16x32_bf16 v[72:75], a[16:19], a[120:123], v[72:75]
    ds_read_b64_tr_b16 a[76:77], v242 offset:24576
    s_mov_b32 m0, s35
    v_mfma_f32_16x16x32_bf16 v[76:79], a[16:19], a[124:127], v[76:79]
    buffer_load_dwordx4 v232, s[20:23], s33 offen offset:0 lds
    v_mfma_f32_16x16x32_bf16 v[80:83], a[20:23], a[112:115], v[80:83]
    ds_read_b64_tr_b16 a[78:79], v242 offset:25600
    v_mfma_f32_16x16x32_bf16 v[84:87], a[20:23], a[116:119], v[84:87]
    ds_read_b64_tr_b16 a[80:81], v243 offset:8192
    v_mfma_f32_16x16x32_bf16 v[88:91], a[20:23], a[120:123], v[88:91]
    ds_read_b64_tr_b16 a[82:83], v243 offset:9216
    v_mfma_f32_16x16x32_bf16 v[92:95], a[20:23], a[124:127], v[92:95]
    buffer_load_dwordx4 v233, s[20:23], s33 offen offset:1024 lds
    v_mfma_f32_16x16x32_bf16 v[96:99], a[24:27], a[112:115], v[96:99]
    ds_read_b64_tr_b16 a[84:85], v243 offset:24576
    v_mfma_f32_16x16x32_bf16 v[100:103], a[24:27], a[116:119], v[100:103]
    ds_read_b64_tr_b16 a[86:87], v243 offset:25600
    v_mfma_f32_16x16x32_bf16 v[104:107], a[24:27], a[120:123], v[104:107]
    ds_read_b64_tr_b16 a[88:89], v244 offset:8192
    v_mfma_f32_16x16x32_bf16 v[108:111], a[24:27], a[124:127], v[108:111]
    buffer_load_dwordx4 v234, s[20:23], s33 offen offset:2048 lds
    v_mfma_f32_16x16x32_bf16 v[112:115], a[28:31], a[112:115], v[112:115]
    ds_read_b64_tr_b16 a[90:91], v244 offset:9216
    v_mfma_f32_16x16x32_bf16 v[116:119], a[28:31], a[116:119], v[116:119]
    ds_read_b64_tr_b16 a[92:93], v244 offset:24576
    v_mfma_f32_16x16x32_bf16 v[120:123], a[28:31], a[120:123], v[120:123]
    ds_read_b64_tr_b16 a[94:95], v244 offset:25600
    v_mfma_f32_16x16x32_bf16 v[124:127], a[28:31], a[124:127], v[124:127]
    buffer_load_dwordx4 v235, s[20:23], s33 offen offset:3072 lds
    v_mfma_f32_16x16x32_bf16 v[128:131], a[32:35], a[112:115], v[128:131]
    ds_read_b64_tr_b16 a[96:97], v245 offset:8192
    v_mfma_f32_16x16x32_bf16 v[132:135], a[32:35], a[116:119], v[132:135]
    ds_read_b64_tr_b16 a[98:99], v245 offset:9216
    v_mfma_f32_16x16x32_bf16 v[136:139], a[32:35], a[120:123], v[136:139]
    ds_read_b64_tr_b16 a[100:101], v245 offset:24576
    s_add_u32 m0, s35, 4096
    v_mfma_f32_16x16x32_bf16 v[140:143], a[32:35], a[124:127], v[140:143]
    buffer_load_dwordx4 v236, s[20:23], s33 offen offset:0 lds
    v_mfma_f32_16x16x32_bf16 v[144:147], a[36:39], a[112:115], v[144:147]
    ds_read_b64_tr_b16 a[102:103], v245 offset:25600
    v_mfma_f32_16x16x32_bf16 v[148:151], a[36:39], a[116:119], v[148:151]
    ds_read_b64_tr_b16 a[104:105], v246 offset:8192
    v_mfma_f32_16x16x32_bf16 v[152:155], a[36:39], a[120:123], v[152:155]
    ds_read_b64_tr_b16 a[106:107], v246 offset:9216
    v_mfma_f32_16x16x32_bf16 v[156:159], a[36:39], a[124:127], v[156:159]
    buffer_load_dwordx4 v237, s[20:23], s33 offen offset:1024 lds
    v_mfma_f32_16x16x32_bf16 v[160:163], a[40:43], a[112:115], v[160:163]
    ds_read_b64_tr_b16 a[108:109], v246 offset:24576
    v_mfma_f32_16x16x32_bf16 v[164:167], a[40:43], a[116:119], v[164:167]
    ds_read_b64_tr_b16 a[110:111], v246 offset:25600
    v_mfma_f32_16x16x32_bf16 v[168:171], a[40:43], a[120:123], v[168:171]
    v_add_u32 v240, s37, v240
    v_mfma_f32_16x16x32_bf16 v[172:175], a[40:43], a[124:127], v[172:175]
    buffer_load_dwordx4 v238, s[20:23], s33 offen offset:2048 lds
    v_add_u32 v241, s37, v241
    v_mfma_f32_16x16x32_bf16 v[176:179], a[44:47], a[112:115], v[176:179]
    v_add_u32 v242, s37, v242
    v_mfma_f32_16x16x32_bf16 v[180:183], a[44:47], a[116:119], v[180:183]
    v_add_u32 v243, s37, v243
    v_mfma_f32_16x16x32_bf16 v[184:187], a[44:47], a[120:123], v[184:187]
    buffer_load_dwordx4 v239, s[20:23], s33 offen offset:3072 lds
    v_add_u32 v244, s37, v244
    v_mfma_f32_16x16x32_bf16 v[188:191], a[44:47], a[124:127], v[188:191]
    v_add_u32 v245, s37, v245
    s_xor_b32 s35, s35, 0x8000
    s_add_u32 s33, s33, s59
    v_mfma_f32_16x16x32_bf16 v[192:195], a[48:51], a[112:115], v[192:195]
    v_add_u32 v246, s37, v246
    v_mfma_f32_16x16x32_bf16 v[196:199], a[48:51], a[116:119], v[196:199]
    buffer_load_dword a144, v255, s[24:27], s58 offen
    v_xor_b32 v247, 0x8000, v247
    v_mfma_f32_16x16x32_bf16 v[200:203], a[48:51], a[120:123], v[200:203]
    v_xor_b32 v248, 0x8000, v248
    v_mfma_f32_16x16x32_bf16 v[204:207], a[48:51], a[124:127], v[204:207]
    buffer_load_dword a144, v249, s[20:23], s57 offen
    v_mfma_f32_16x16x32_bf16 v[208:211], a[52:55], a[112:115], v[208:211]
    v_mfma_f32_16x16x32_bf16 v[212:215], a[52:55], a[116:119], v[212:215]
    buffer_load_dword a144, v250, s[12:15], s43 offen
    v_mfma_f32_16x16x32_bf16 v[216:219], a[52:55], a[120:123], v[216:219]
    s_add_u32 s58, s58, 458752
    s_add_u32 s43, s43, 524288
    s_add_u32 s57, s57, 128
    v_mfma_f32_16x16x32_bf16 v[220:223], a[52:55], a[124:127], v[220:223]
    s_min_u32 s57, s57, 1920
    s_min_u32 s58, s58, 6881280
    s_add_u32 s38, s38, 1
    s_cmp_lt_u32 s38, 14
    s_cbranch_scc1 L1_loop
    s_waitcnt vmcnt(22) lgkmcnt(0)
    s_barrier
    v_mfma_f32_16x16x32_bf16 v[0:3], a[56:59], a[128:131], v[0:3]
    ds_read_b128 a[112:115], v247 offset:0
    s_lshr_b32 s4, s3, 2
    s_and_b32 s57, s3, 3
    v_lshlrev_b32 v233, 6, v251
    v_mfma_f32_16x16x32_bf16 v[4:7], a[56:59], a[132:135], v[4:7]
    ds_read_b128 a[116:119], v247 offset:2048
    s_lshl_b32 s5, s57, 2
    s_and_b32 s6, s48, 3
    v_lshrrev_b32 v234, 4, v251
    v_mfma_f32_16x16x32_bf16 v[8:11], a[56:59], a[136:139], v[8:11]
    ds_read_b128 a[120:123], v247 offset:4096
    s_add_u32 s5, s5, s6
    s_lshr_b32 s6, s48, 2
    v_bfe_u32 v235, v251, 1, 3
    v_mfma_f32_16x16x32_bf16 v[12:15], a[56:59], a[140:143], v[12:15]
    s_mul_i32 s7, s4, 3670016
    s_add_u32 s20, s10, s7
    v_xor_b32 v235, v235, v234
    v_mfma_f32_16x16x32_bf16 v[16:19], a[60:63], a[128:131], v[16:19]
    ds_read_b128 a[124:127], v247 offset:6144
    s_addc_u32 s21, s11, 0
    s_and_b32 s21, s21, 0xffff
    v_and_b32 v236, 1, v251
    v_mfma_f32_16x16x32_bf16 v[20:23], a[60:63], a[132:135], v[20:23]
    ds_read_b64_tr_b16 a[0:1], v240 offset:0
    s_mov_b32 s22, 3670016
    s_lshl_b32 s7, s32, 16
    v_lshlrev_b32 v236, 4, v236
    v_mfma_f32_16x16x32_bf16 v[24:27], a[60:63], a[136:139], v[24:27]
    ds_read_b64_tr_b16 a[2:3], v240 offset:1024
    s_lshl_b32 s8, s6, 8
    s_add_u32 s7, s7, s8
    v_lshl_add_u32 v236, v234, 11, v236
    v_mfma_f32_16x16x32_bf16 v[28:31], a[60:63], a[140:143], v[28:31]
    v_lshl_add_u32 v236, v235, 5, v236
    s_lshl_b32 s8, s48, 2
    s_add_u32 s8, s8, s32
    v_mfma_f32_16x16x32_bf16 v[32:35], a[64:67], a[128:131], v[32:35]
    ds_read_b64_tr_b16 a[4:5], v240 offset:16384
    v_add_u32 v236, s7, v236
    s_mul_i32 s58, s57, 917504
    s_lshl_b32 s8, s8, 13
    v_mfma_f32_16x16x32_bf16 v[36:39], a[64:67], a[132:135], v[36:39]
    ds_read_b64_tr_b16 a[6:7], v240 offset:17408
    v_xor_b32 v234, 128, v236
    s_add_u32 s8, s8, s58
    s_sub_u32 s9, s8, 3670016
    v_mfma_f32_16x16x32_bf16 v[40:43], a[64:67], a[136:139], v[40:43]
    ds_read_b64_tr_b16 a[8:9], v241 offset:0
    v_add_u32 v224, 0, v236
    s_cselect_b32 s8, s8, s9
    s_add_u32 s9, s8, 4096
    v_mfma_f32_16x16x32_bf16 v[44:47], a[64:67], a[140:143], v[44:47]
    v_add_u32 v225, 7168, v236
    buffer_load_dword a144, v233, s[20:23], s8 offen
    v_mfma_f32_16x16x32_bf16 v[48:51], a[68:71], a[128:131], v[48:51]
    ds_read_b64_tr_b16 a[10:11], v241 offset:1024
    v_add_u32 v226, 14336, v234
    v_mfma_f32_16x16x32_bf16 v[52:55], a[68:71], a[132:135], v[52:55]
    ds_read_b64_tr_b16 a[12:13], v241 offset:16384
    v_add_u32 v227, 21504, v234
    v_mfma_f32_16x16x32_bf16 v[56:59], a[68:71], a[136:139], v[56:59]
    ds_read_b64_tr_b16 a[14:15], v241 offset:17408
    v_add_u32 v228, 32768, v236
    v_mfma_f32_16x16x32_bf16 v[60:63], a[68:71], a[140:143], v[60:63]
    v_add_u32 v229, 39936, v236
    buffer_load_dword a144, v233, s[20:23], s9 offen
    v_mfma_f32_16x16x32_bf16 v[64:67], a[72:75], a[128:131], v[64:67]
    ds_read_b64_tr_b16 a[16:17], v242 offset:0
    v_add_u32 v230, 47104, v234
    v_mfma_f32_16x16x32_bf16 v[68:71], a[72:75], a[132:135], v[68:71]
    ds_read_b64_tr_b16 a[18:19], v242 offset:1024
    v_add_u32 v231, 54272, v234
    v_mfma_f32_16x16x32_bf16 v[72:75], a[72:75], a[136:139], v[72:75]
    ds_read_b64_tr_b16 a[20:21], v242 offset:16384
    v_mfma_f32_16x16x32_bf16 v[76:79], a[72:75], a[140:143], v[76:79]
    v_mfma_f32_16x16x32_bf16 v[80:83], a[76:79], a[128:131], v[80:83]
    ds_read_b64_tr_b16 a[22:23], v242 offset:17408
    v_mfma_f32_16x16x32_bf16 v[84:87], a[76:79], a[132:135], v[84:87]
    ds_read_b64_tr_b16 a[24:25], v243 offset:0
    v_mfma_f32_16x16x32_bf16 v[88:91], a[76:79], a[136:139], v[88:91]
    ds_read_b64_tr_b16 a[26:27], v243 offset:1024
    v_mfma_f32_16x16x32_bf16 v[92:95], a[76:79], a[140:143], v[92:95]
    v_mfma_f32_16x16x32_bf16 v[96:99], a[80:83], a[128:131], v[96:99]
    ds_read_b64_tr_b16 a[28:29], v243 offset:16384
    v_mfma_f32_16x16x32_bf16 v[100:103], a[80:83], a[132:135], v[100:103]
    ds_read_b64_tr_b16 a[30:31], v243 offset:17408
    v_mfma_f32_16x16x32_bf16 v[104:107], a[80:83], a[136:139], v[104:107]
    ds_read_b64_tr_b16 a[32:33], v244 offset:0
    v_mfma_f32_16x16x32_bf16 v[108:111], a[80:83], a[140:143], v[108:111]
    v_mfma_f32_16x16x32_bf16 v[112:115], a[84:87], a[128:131], v[112:115]
    ds_read_b64_tr_b16 a[34:35], v244 offset:1024
    v_mfma_f32_16x16x32_bf16 v[116:119], a[84:87], a[132:135], v[116:119]
    ds_read_b64_tr_b16 a[36:37], v244 offset:16384
    v_mfma_f32_16x16x32_bf16 v[120:123], a[84:87], a[136:139], v[120:123]
    ds_read_b64_tr_b16 a[38:39], v244 offset:17408
    v_mfma_f32_16x16x32_bf16 v[124:127], a[84:87], a[140:143], v[124:127]
    v_mfma_f32_16x16x32_bf16 v[128:131], a[88:91], a[128:131], v[128:131]
    ds_read_b64_tr_b16 a[40:41], v245 offset:0
    v_mfma_f32_16x16x32_bf16 v[132:135], a[88:91], a[132:135], v[132:135]
    ds_read_b64_tr_b16 a[42:43], v245 offset:1024
    v_mfma_f32_16x16x32_bf16 v[136:139], a[88:91], a[136:139], v[136:139]
    ds_read_b64_tr_b16 a[44:45], v245 offset:16384
    v_mfma_f32_16x16x32_bf16 v[140:143], a[88:91], a[140:143], v[140:143]
    v_mfma_f32_16x16x32_bf16 v[144:147], a[92:95], a[128:131], v[144:147]
    ds_read_b64_tr_b16 a[46:47], v245 offset:17408
    v_mfma_f32_16x16x32_bf16 v[148:151], a[92:95], a[132:135], v[148:151]
    ds_read_b64_tr_b16 a[48:49], v246 offset:0
    v_mfma_f32_16x16x32_bf16 v[152:155], a[92:95], a[136:139], v[152:155]
    ds_read_b64_tr_b16 a[50:51], v246 offset:1024
    v_mfma_f32_16x16x32_bf16 v[156:159], a[92:95], a[140:143], v[156:159]
    v_mfma_f32_16x16x32_bf16 v[160:163], a[96:99], a[128:131], v[160:163]
    ds_read_b64_tr_b16 a[52:53], v246 offset:16384
    v_mfma_f32_16x16x32_bf16 v[164:167], a[96:99], a[132:135], v[164:167]
    ds_read_b64_tr_b16 a[54:55], v246 offset:17408
    v_mfma_f32_16x16x32_bf16 v[168:171], a[96:99], a[136:139], v[168:171]
    v_mfma_f32_16x16x32_bf16 v[172:175], a[96:99], a[140:143], v[172:175]
    v_mfma_f32_16x16x32_bf16 v[176:179], a[100:103], a[128:131], v[176:179]
    v_mfma_f32_16x16x32_bf16 v[180:183], a[100:103], a[132:135], v[180:183]
    v_mfma_f32_16x16x32_bf16 v[184:187], a[100:103], a[136:139], v[184:187]
    v_mfma_f32_16x16x32_bf16 v[188:191], a[100:103], a[140:143], v[188:191]
    v_mfma_f32_16x16x32_bf16 v[192:195], a[104:107], a[128:131], v[192:195]
    v_mfma_f32_16x16x32_bf16 v[196:199], a[104:107], a[132:135], v[196:199]
    v_mfma_f32_16x16x32_bf16 v[200:203], a[104:107], a[136:139], v[200:203]
    v_mfma_f32_16x16x32_bf16 v[204:207], a[104:107], a[140:143], v[204:207]
    v_mfma_f32_16x16x32_bf16 v[208:211], a[108:111], a[128:131], v[208:211]
    v_mfma_f32_16x16x32_bf16 v[212:215], a[108:111], a[132:135], v[212:215]
    v_mfma_f32_16x16x32_bf16 v[216:219], a[108:111], a[136:139], v[216:219]
    v_mfma_f32_16x16x32_bf16 v[220:223], a[108:111], a[140:143], v[220:223]
    s_waitcnt lgkmcnt(0)
    v_mfma_f32_16x16x32_bf16 v[0:3], a[0:3], a[112:115], v[0:3]
    ds_read_b128 a[128:131], v248 offset:0
    v_mfma_f32_16x16x32_bf16 v[4:7], a[0:3], a[116:119], v[4:7]
    ds_read_b128 a[132:135], v248 offset:2048
    v_mfma_f32_16x16x32_bf16 v[8:11], a[0:3], a[120:123], v[8:11]
    ds_read_b128 a[136:139], v248 offset:4096
    v_mfma_f32_16x16x32_bf16 v[12:15], a[0:3], a[124:127], v[12:15]
    v_mfma_f32_16x16x32_bf16 v[16:19], a[4:7], a[112:115], v[16:19]
    ds_read_b128 a[140:143], v248 offset:6144
    v_mfma_f32_16x16x32_bf16 v[20:23], a[4:7], a[116:119], v[20:23]
    ds_read_b64_tr_b16 a[56:57], v240 offset:8192
    v_mfma_f32_16x16x32_bf16 v[24:27], a[4:7], a[120:123], v[24:27]
    ds_read_b64_tr_b16 a[58:59], v240 offset:9216
    v_mfma_f32_16x16x32_bf16 v[28:31], a[4:7], a[124:127], v[28:31]
    v_mfma_f32_16x16x32_bf16 v[32:35], a[8:11], a[112:115], v[32:35]
    ds_read_b64_tr_b16 a[60:61], v240 offset:24576
    v_mfma_f32_16x16x32_bf16 v[36:39], a[8:11], a[116:119], v[36:39]
    ds_read_b64_tr_b16 a[62:63], v240 offset:25600
    v_mfma_f32_16x16x32_bf16 v[40:43], a[8:11], a[120:123], v[40:43]
    ds_read_b64_tr_b16 a[64:65], v241 offset:8192
    v_mfma_f32_16x16x32_bf16 v[44:47], a[8:11], a[124:127], v[44:47]
    v_mfma_f32_16x16x32_bf16 v[48:51], a[12:15], a[112:115], v[48:51]
    ds_read_b64_tr_b16 a[66:67], v241 offset:9216
    v_mfma_f32_16x16x32_bf16 v[52:55], a[12:15], a[116:119], v[52:55]
    ds_read_b64_tr_b16 a[68:69], v241 offset:24576
    v_mfma_f32_16x16x32_bf16 v[56:59], a[12:15], a[120:123], v[56:59]
    ds_read_b64_tr_b16 a[70:71], v241 offset:25600
    v_mfma_f32_16x16x32_bf16 v[60:63], a[12:15], a[124:127], v[60:63]
    v_mfma_f32_16x16x32_bf16 v[64:67], a[16:19], a[112:115], v[64:67]
    ds_read_b64_tr_b16 a[72:73], v242 offset:8192
    v_mfma_f32_16x16x32_bf16 v[68:71], a[16:19], a[116:119], v[68:71]
    ds_read_b64_tr_b16 a[74:75], v242 offset:9216
    v_mfma_f32_16x16x32_bf16 v[72:75], a[16:19], a[120:123], v[72:75]
    ds_read_b64_tr_b16 a[76:77], v242 offset:24576
    s_add_u32 m0, s40, 98304
    s_add_u32 s41, s58, 0
    v_mfma_f32_16x16x32_bf16 v[76:79], a[16:19], a[124:127], v[76:79]
    buffer_load_dwordx4 v224, s[20:23], s41 offen offset:0 lds
    v_mfma_f32_16x16x32_bf16 v[80:83], a[20:23], a[112:115], v[80:83]
    ds_read_b64_tr_b16 a[78:79], v242 offset:25600
    v_mfma_f32_16x16x32_bf16 v[84:87], a[20:23], a[116:119], v[84:87]
    ds_read_b64_tr_b16 a[80:81], v243 offset:8192
    v_mfma_f32_16x16x32_bf16 v[88:91], a[20:23], a[120:123], v[88:91]
    ds_read_b64_tr_b16 a[82:83], v243 offset:9216
    v_mfma_f32_16x16x32_bf16 v[92:95], a[20:23], a[124:127], v[92:95]
    buffer_load_dwordx4 v225, s[20:23], s41 offen offset:1024 lds
    v_mfma_f32_16x16x32_bf16 v[96:99], a[24:27], a[112:115], v[96:99]
    ds_read_b64_tr_b16 a[84:85], v243 offset:24576
    v_mfma_f32_16x16x32_bf16 v[100:103], a[24:27], a[116:119], v[100:103]
    ds_read_b64_tr_b16 a[86:87], v243 offset:25600
    v_mfma_f32_16x16x32_bf16 v[104:107], a[24:27], a[120:123], v[104:107]
    ds_read_b64_tr_b16 a[88:89], v244 offset:8192
    v_mfma_f32_16x16x32_bf16 v[108:111], a[24:27], a[124:127], v[108:111]
    buffer_load_dwordx4 v226, s[20:23], s41 offen offset:2048 lds
    v_mfma_f32_16x16x32_bf16 v[112:115], a[28:31], a[112:115], v[112:115]
    ds_read_b64_tr_b16 a[90:91], v244 offset:9216
    v_mfma_f32_16x16x32_bf16 v[116:119], a[28:31], a[116:119], v[116:119]
    ds_read_b64_tr_b16 a[92:93], v244 offset:24576
    v_mfma_f32_16x16x32_bf16 v[120:123], a[28:31], a[120:123], v[120:123]
    ds_read_b64_tr_b16 a[94:95], v244 offset:25600
    v_mfma_f32_16x16x32_bf16 v[124:127], a[28:31], a[124:127], v[124:127]
    buffer_load_dwordx4 v227, s[20:23], s41 offen offset:3072 lds
    v_mfma_f32_16x16x32_bf16 v[128:131], a[32:35], a[112:115], v[128:131]
    ds_read_b64_tr_b16 a[96:97], v245 offset:8192
    v_mfma_f32_16x16x32_bf16 v[132:135], a[32:35], a[116:119], v[132:135]
    ds_read_b64_tr_b16 a[98:99], v245 offset:9216
    v_mfma_f32_16x16x32_bf16 v[136:139], a[32:35], a[120:123], v[136:139]
    ds_read_b64_tr_b16 a[100:101], v245 offset:24576
    s_add_u32 m0, s40, 102400
    v_mfma_f32_16x16x32_bf16 v[140:143], a[32:35], a[124:127], v[140:143]
    buffer_load_dwordx4 v228, s[20:23], s41 offen offset:0 lds
    v_mfma_f32_16x16x32_bf16 v[144:147], a[36:39], a[112:115], v[144:147]
    ds_read_b64_tr_b16 a[102:103], v245 offset:25600
    v_mfma_f32_16x16x32_bf16 v[148:151], a[36:39], a[116:119], v[148:151]
    ds_read_b64_tr_b16 a[104:105], v246 offset:8192
    v_mfma_f32_16x16x32_bf16 v[152:155], a[36:39], a[120:123], v[152:155]
    ds_read_b64_tr_b16 a[106:107], v246 offset:9216
    v_mfma_f32_16x16x32_bf16 v[156:159], a[36:39], a[124:127], v[156:159]
    buffer_load_dwordx4 v229, s[20:23], s41 offen offset:1024 lds
    v_mfma_f32_16x16x32_bf16 v[160:163], a[40:43], a[112:115], v[160:163]
    ds_read_b64_tr_b16 a[108:109], v246 offset:24576
    v_mfma_f32_16x16x32_bf16 v[164:167], a[40:43], a[116:119], v[164:167]
    ds_read_b64_tr_b16 a[110:111], v246 offset:25600
    v_mfma_f32_16x16x32_bf16 v[168:171], a[40:43], a[120:123], v[168:171]
    v_add_u32 v240, 4294901760, v240
    v_mfma_f32_16x16x32_bf16 v[172:175], a[40:43], a[124:127], v[172:175]
    buffer_load_dwordx4 v230, s[20:23], s41 offen offset:2048 lds
    v_add_u32 v241, 4294901760, v241
    v_mfma_f32_16x16x32_bf16 v[176:179], a[44:47], a[112:115], v[176:179]
    v_add_u32 v242, 4294901760, v242
    v_mfma_f32_16x16x32_bf16 v[180:183], a[44:47], a[116:119], v[180:183]
    v_add_u32 v243, 4294901760, v243
    v_mfma_f32_16x16x32_bf16 v[184:187], a[44:47], a[120:123], v[184:187]
    v_add_u32 v244, 4294901760, v244
    v_mfma_f32_16x16x32_bf16 v[188:191], a[44:47], a[124:127], v[188:191]
    buffer_load_dwordx4 v231, s[20:23], s41 offen offset:3072 lds
    v_add_u32 v245, 4294901760, v245
    v_mfma_f32_16x16x32_bf16 v[192:195], a[48:51], a[112:115], v[192:195]
    v_add_u32 v246, 4294901760, v246
    v_mfma_f32_16x16x32_bf16 v[196:199], a[48:51], a[116:119], v[196:199]
    v_xor_b32 v247, 0x8000, v247
    v_mfma_f32_16x16x32_bf16 v[200:203], a[48:51], a[120:123], v[200:203]
    v_xor_b32 v248, 0x8000, v248
    v_mfma_f32_16x16x32_bf16 v[204:207], a[48:51], a[124:127], v[204:207]
    v_mfma_f32_16x16x32_bf16 v[208:211], a[52:55], a[112:115], v[208:211]
    v_mfma_f32_16x16x32_bf16 v[212:215], a[52:55], a[116:119], v[212:215]
    v_mfma_f32_16x16x32_bf16 v[216:219], a[52:55], a[120:123], v[216:219]
    v_mfma_f32_16x16x32_bf16 v[220:223], a[52:55], a[124:127], v[220:223]
    s_waitcnt vmcnt(13) lgkmcnt(0)
    s_barrier
    v_mfma_f32_16x16x32_bf16 v[0:3], a[56:59], a[128:131], v[0:3]
    ds_read_b128 a[112:115], v247 offset:0
    s_lshl_b32 s7, s51, 1
    v_mfma_f32_16x16x32_bf16 v[4:7], a[56:59], a[132:135], v[4:7]
    ds_read_b128 a[116:119], v247 offset:2048
    s_mul_i32 s7, s7, 229376
    v_mfma_f32_16x16x32_bf16 v[8:11], a[56:59], a[136:139], v[8:11]
    ds_read_b128 a[120:123], v247 offset:4096
    s_add_u32 m0, s40, 131072
    s_add_u32 s41, s58, 262144
    v_mfma_f32_16x16x32_bf16 v[12:15], a[56:59], a[140:143], v[12:15]
    buffer_load_dwordx4 v224, s[20:23], s41 offen offset:0 lds
    v_mfma_f32_16x16x32_bf16 v[16:19], a[60:63], a[128:131], v[16:19]
    ds_read_b128 a[124:127], v247 offset:6144
    s_mul_i32 s8, s50, 7168
    v_mfma_f32_16x16x32_bf16 v[20:23], a[60:63], a[132:135], v[20:23]
    ds_read_b64_tr_b16 a[0:1], v240 offset:0
    s_add_u32 s7, s7, s8
    v_mfma_f32_16x16x32_bf16 v[24:27], a[60:63], a[136:139], v[24:27]
    ds_read_b64_tr_b16 a[2:3], v240 offset:1024
    v_mfma_f32_16x16x32_bf16 v[28:31], a[60:63], a[140:143], v[28:31]
    buffer_load_dwordx4 v225, s[20:23], s41 offen offset:1024 lds
    v_mfma_f32_16x16x32_bf16 v[32:35], a[64:67], a[128:131], v[32:35]
    ds_read_b64_tr_b16 a[4:5], v240 offset:16384
    v_add_u32 v232, s7, v254
    v_mfma_f32_16x16x32_bf16 v[36:39], a[64:67], a[132:135], v[36:39]
    ds_read_b64_tr_b16 a[6:7], v240 offset:17408
    s_mov_b32 s42, s62
    v_mfma_f32_16x16x32_bf16 v[40:43], a[64:67], a[136:139], v[40:43]
    ds_read_b64_tr_b16 a[8:9], v241 offset:0
    v_mfma_f32_16x16x32_bf16 v[44:47], a[64:67], a[140:143], v[44:47]
    buffer_load_dwordx4 v226, s[20:23], s41 offen offset:2048 lds
    v_mfma_f32_16x16x32_bf16 v[48:51], a[68:71], a[128:131], v[48:51]
    ds_read_b64_tr_b16 a[10:11], v241 offset:1024
    s_add_u32 s43, s42, 4096
    v_mfma_f32_16x16x32_bf16 v[52:55], a[68:71], a[132:135], v[52:55]
    ds_read_b64_tr_b16 a[12:13], v241 offset:16384
    s_lshl_b32 s8, s5, 2
    v_and_b32 v237, 60, v253
    v_mfma_f32_16x16x32_bf16 v[56:59], a[68:71], a[136:139], v[56:59]
    ds_read_b64_tr_b16 a[14:15], v241 offset:17408
    s_add_u32 s8, s8, s4
    v_bfe_u32 v234, v251, 4, 1
    v_mfma_f32_16x16x32_bf16 v[60:63], a[68:71], a[140:143], v[60:63]
    buffer_load_dwordx4 v227, s[20:23], s41 offen offset:3072 lds
    s_lshl_b32 s8, s8, 7
    v_lshl_add_u32 v237, v234, 8, v237
    v_mfma_f32_16x16x32_bf16 v[64:67], a[72:75], a[128:131], v[64:67]
    ds_read_b64_tr_b16 a[16:17], v242 offset:0
    s_add_u32 s8, s8, 33554432
    v_mfma_f32_16x16x32_bf16 v[68:71], a[72:75], a[132:135], v[68:71]
    ds_read_b64_tr_b16 a[18:19], v242 offset:1024
    v_add_u32 v237, s8, v237
    v_mfma_f32_16x16x32_bf16 v[72:75], a[72:75], a[136:139], v[72:75]
    ds_read_b64_tr_b16 a[20:21], v242 offset:16384
    s_add_u32 m0, s40, 135168
    v_mfma_f32_16x16x32_bf16 v[76:79], a[72:75], a[140:143], v[76:79]
    buffer_load_dwordx4 v228, s[20:23], s41 offen offset:0 lds
    v_mfma_f32_16x16x32_bf16 v[80:83], a[76:79], a[128:131], v[80:83]
    ds_read_b64_tr_b16 a[22:23], v242 offset:17408
    v_mfma_f32_16x16x32_bf16 v[84:87], a[76:79], a[132:135], v[84:87]
    ds_read_b64_tr_b16 a[24:25], v243 offset:0
    v_mfma_f32_16x16x32_bf16 v[88:91], a[76:79], a[136:139], v[88:91]
    ds_read_b64_tr_b16 a[26:27], v243 offset:1024
    v_mfma_f32_16x16x32_bf16 v[92:95], a[76:79], a[140:143], v[92:95]
    buffer_load_dwordx4 v229, s[20:23], s41 offen offset:1024 lds
    v_mfma_f32_16x16x32_bf16 v[96:99], a[80:83], a[128:131], v[96:99]
    ds_read_b64_tr_b16 a[28:29], v243 offset:16384
    v_mfma_f32_16x16x32_bf16 v[100:103], a[80:83], a[132:135], v[100:103]
    ds_read_b64_tr_b16 a[30:31], v243 offset:17408
    v_mfma_f32_16x16x32_bf16 v[104:107], a[80:83], a[136:139], v[104:107]
    ds_read_b64_tr_b16 a[32:33], v244 offset:0
    v_mfma_f32_16x16x32_bf16 v[108:111], a[80:83], a[140:143], v[108:111]
    buffer_load_dwordx4 v230, s[20:23], s41 offen offset:2048 lds
    v_mfma_f32_16x16x32_bf16 v[112:115], a[84:87], a[128:131], v[112:115]
    ds_read_b64_tr_b16 a[34:35], v244 offset:1024
    v_mfma_f32_16x16x32_bf16 v[116:119], a[84:87], a[132:135], v[116:119]
    ds_read_b64_tr_b16 a[36:37], v244 offset:16384
    v_mfma_f32_16x16x32_bf16 v[120:123], a[84:87], a[136:139], v[120:123]
    ds_read_b64_tr_b16 a[38:39], v244 offset:17408
    v_mfma_f32_16x16x32_bf16 v[124:127], a[84:87], a[140:143], v[124:127]
    buffer_load_dwordx4 v231, s[20:23], s41 offen offset:3072 lds
    v_mfma_f32_16x16x32_bf16 v[128:131], a[88:91], a[128:131], v[128:131]
    ds_read_b64_tr_b16 a[40:41], v245 offset:0
    v_mfma_f32_16x16x32_bf16 v[132:135], a[88:91], a[132:135], v[132:135]
    ds_read_b64_tr_b16 a[42:43], v245 offset:1024
    v_mfma_f32_16x16x32_bf16 v[136:139], a[88:91], a[136:139], v[136:139]
    ds_read_b64_tr_b16 a[44:45], v245 offset:16384
    v_mfma_f32_16x16x32_bf16 v[140:143], a[88:91], a[140:143], v[140:143]
    buffer_load_dword v238, v237, s[28:31], 0 offen sc1
    v_mfma_f32_16x16x32_bf16 v[144:147], a[92:95], a[128:131], v[144:147]
    ds_read_b64_tr_b16 a[46:47], v245 offset:17408
    v_mfma_f32_16x16x32_bf16 v[148:151], a[92:95], a[132:135], v[148:151]
    ds_read_b64_tr_b16 a[48:49], v246 offset:0
    v_mfma_f32_16x16x32_bf16 v[152:155], a[92:95], a[136:139], v[152:155]
    ds_read_b64_tr_b16 a[50:51], v246 offset:1024
    v_mfma_f32_16x16x32_bf16 v[156:159], a[92:95], a[140:143], v[156:159]
    v_mfma_f32_16x16x32_bf16 v[160:163], a[96:99], a[128:131], v[160:163]
    ds_read_b64_tr_b16 a[52:53], v246 offset:16384
    v_mfma_f32_16x16x32_bf16 v[164:167], a[96:99], a[132:135], v[164:167]
    ds_read_b64_tr_b16 a[54:55], v246 offset:17408
    v_mfma_f32_16x16x32_bf16 v[168:171], a[96:99], a[136:139], v[168:171]
    v_mfma_f32_16x16x32_bf16 v[172:175], a[96:99], a[140:143], v[172:175]
    v_mfma_f32_16x16x32_bf16 v[176:179], a[100:103], a[128:131], v[176:179]
    v_mfma_f32_16x16x32_bf16 v[180:183], a[100:103], a[132:135], v[180:183]
    v_mfma_f32_16x16x32_bf16 v[184:187], a[100:103], a[136:139], v[184:187]
    v_mfma_f32_16x16x32_bf16 v[188:191], a[100:103], a[140:143], v[188:191]
    v_mfma_f32_16x16x32_bf16 v[192:195], a[104:107], a[128:131], v[192:195]
    v_mfma_f32_16x16x32_bf16 v[196:199], a[104:107], a[132:135], v[196:199]
    v_mfma_f32_16x16x32_bf16 v[200:203], a[104:107], a[136:139], v[200:203]
    v_mfma_f32_16x16x32_bf16 v[204:207], a[104:107], a[140:143], v[204:207]
    v_mfma_f32_16x16x32_bf16 v[208:211], a[108:111], a[128:131], v[208:211]
    v_mfma_f32_16x16x32_bf16 v[212:215], a[108:111], a[132:135], v[212:215]
    v_mfma_f32_16x16x32_bf16 v[216:219], a[108:111], a[136:139], v[216:219]
    buffer_load_dword v254, v253, s[52:55], 0 offen sc1
    v_mfma_f32_16x16x32_bf16 v[220:223], a[108:111], a[140:143], v[220:223]
L1_done:
    s_waitcnt lgkmcnt(0)
    v_mfma_f32_16x16x32_bf16 v[0:3], a[0:3], a[112:115], v[0:3]
    ds_read_b128 a[128:131], v248 offset:0
    v_mfma_f32_16x16x32_bf16 v[4:7], a[0:3], a[116:119], v[4:7]
    ds_read_b128 a[132:135], v248 offset:2048
    v_mfma_f32_16x16x32_bf16 v[8:11], a[0:3], a[120:123], v[8:11]
    ds_read_b128 a[136:139], v248 offset:4096
    v_mfma_f32_16x16x32_bf16 v[12:15], a[0:3], a[124:127], v[12:15]
    ds_read_b128 a[140:143], v248 offset:6144
    v_mfma_f32_16x16x32_bf16 v[16:19], a[4:7], a[112:115], v[16:19]
    ds_read_b64_tr_b16 a[56:57], v240 offset:8192
    v_mfma_f32_16x16x32_bf16 v[20:23], a[4:7], a[116:119], v[20:23]
    ds_read_b64_tr_b16 a[58:59], v240 offset:9216
    v_mfma_f32_16x16x32_bf16 v[24:27], a[4:7], a[120:123], v[24:27]
    ds_read_b64_tr_b16 a[60:61], v240 offset:24576
    v_mfma_f32_16x16x32_bf16 v[28:31], a[4:7], a[124:127], v[28:31]
    ds_read_b64_tr_b16 a[62:63], v240 offset:25600
    v_mfma_f32_16x16x32_bf16 v[32:35], a[8:11], a[112:115], v[32:35]
    ds_read_b64_tr_b16 a[64:65], v241 offset:8192
    v_mfma_f32_16x16x32_bf16 v[36:39], a[8:11], a[116:119], v[36:39]
    ds_read_b64_tr_b16 a[66:67], v241 offset:9216
    v_mfma_f32_16x16x32_bf16 v[40:43], a[8:11], a[120:123], v[40:43]
    ds_read_b64_tr_b16 a[68:69], v241 offset:24576
    v_mfma_f32_16x16x32_bf16 v[44:47], a[8:11], a[124:127], v[44:47]
    ds_read_b64_tr_b16 a[70:71], v241 offset:25600
    v_mfma_f32_16x16x32_bf16 v[48:51], a[12:15], a[112:115], v[48:51]
    ds_read_b64_tr_b16 a[72:73], v242 offset:8192
    v_mfma_f32_16x16x32_bf16 v[52:55], a[12:15], a[116:119], v[52:55]
    ds_read_b64_tr_b16 a[74:75], v242 offset:9216
    v_mfma_f32_16x16x32_bf16 v[56:59], a[12:15], a[120:123], v[56:59]
    ds_read_b64_tr_b16 a[76:77], v242 offset:24576
    v_mfma_f32_16x16x32_bf16 v[60:63], a[12:15], a[124:127], v[60:63]
    ds_read_b64_tr_b16 a[78:79], v242 offset:25600
    s_waitcnt lgkmcnt(8)
    v_mfma_f32_16x16x32_bf16 v[0:3], a[56:59], a[128:131], v[0:3]
    ds_read_b64_tr_b16 a[80:81], v243 offset:8192
    v_mfma_f32_16x16x32_bf16 v[4:7], a[56:59], a[132:135], v[4:7]
    ds_read_b64_tr_b16 a[82:83], v243 offset:9216
    v_mfma_f32_16x16x32_bf16 v[8:11], a[56:59], a[136:139], v[8:11]
    ds_read_b64_tr_b16 a[84:85], v243 offset:24576
    v_mfma_f32_16x16x32_bf16 v[12:15], a[56:59], a[140:143], v[12:15]
    ds_read_b64_tr_b16 a[86:87], v243 offset:25600
    v_mfma_f32_16x16x32_bf16 v[16:19], a[60:63], a[128:131], v[16:19]
    ds_read_b64_tr_b16 a[88:89], v244 offset:8192
    v_mfma_f32_16x16x32_bf16 v[20:23], a[60:63], a[132:135], v[20:23]
    ds_read_b64_tr_b16 a[90:91], v244 offset:9216
    v_mfma_f32_16x16x32_bf16 v[24:27], a[60:63], a[136:139], v[24:27]
    ds_read_b64_tr_b16 a[92:93], v244 offset:24576
    v_mfma_f32_16x16x32_bf16 v[28:31], a[60:63], a[140:143], v[28:31]
    ds_read_b64_tr_b16 a[94:95], v244 offset:25600
    v_mfma_f32_16x16x32_bf16 v[64:67], a[16:19], a[112:115], v[64:67]
    ds_read_b64_tr_b16 a[96:97], v245 offset:8192
    v_mfma_f32_16x16x32_bf16 v[68:71], a[16:19], a[116:119], v[68:71]
    ds_read_b64_tr_b16 a[98:99], v245 offset:9216
    v_mfma_f32_16x16x32_bf16 v[72:75], a[16:19], a[120:123], v[72:75]
    ds_read_b64_tr_b16 a[100:101], v245 offset:24576
    v_mul_f32 v16, v0, v16
    v_mul_f32 v17, v1, v17
    v_mfma_f32_16x16x32_bf16 v[76:79], a[16:19], a[124:127], v[76:79]
    ds_read_b64_tr_b16 a[102:103], v245 offset:25600
    v_mul_f32 v18, v2, v18
    v_mul_f32 v19, v3, v19
    v_mfma_f32_16x16x32_bf16 v[80:83], a[20:23], a[112:115], v[80:83]
    ds_read_b64_tr_b16 a[104:105], v246 offset:8192
    v_mul_f32 v20, v4, v20
    v_mul_f32 v21, v5, v21
    v_mfma_f32_16x16x32_bf16 v[84:87], a[20:23], a[116:119], v[84:87]
    ds_read_b64_tr_b16 a[106:107], v246 offset:9216
    v_mul_f32 v22, v6, v22
    v_mul_f32 v23, v7, v23
    v_mfma_f32_16x16x32_bf16 v[88:91], a[20:23], a[120:123], v[88:91]
    ds_read_b64_tr_b16 a[108:109], v246 offset:24576
    v_mul_f32 v0, s44, v0
    v_mul_f32 v1, s44, v1
    v_mfma_f32_16x16x32_bf16 v[92:95], a[20:23], a[124:127], v[92:95]
    ds_read_b64_tr_b16 a[110:111], v246 offset:25600
    s_waitcnt lgkmcnt(15)
    v_mul_f32 v2, s44, v2
    v_mul_f32 v3, s44, v3
    v_mfma_f32_16x16x32_bf16 v[32:35], a[64:67], a[128:131], v[32:35]
    v_mul_f32 v4, s44, v4
    v_mul_f32 v5, s44, v5
    v_mfma_f32_16x16x32_bf16 v[36:39], a[64:67], a[132:135], v[36:39]
    v_mul_f32 v6, s44, v6
    v_mul_f32 v7, s44, v7
    v_mfma_f32_16x16x32_bf16 v[40:43], a[64:67], a[136:139], v[40:43]
    v_mul_f32 v24, v8, v24
    v_mul_f32 v25, v9, v25
    v_mfma_f32_16x16x32_bf16 v[44:47], a[64:67], a[140:143], v[44:47]
    v_mul_f32 v26, v10, v26
    v_mul_f32 v27, v11, v27
    v_mfma_f32_16x16x32_bf16 v[48:51], a[68:71], a[128:131], v[48:51]
    v_mul_f32 v28, v12, v28
    v_mul_f32 v29, v13, v29
    v_mfma_f32_16x16x32_bf16 v[52:55], a[68:71], a[132:135], v[52:55]
    v_mul_f32 v30, v14, v30
    v_mul_f32 v31, v15, v31
    v_mfma_f32_16x16x32_bf16 v[56:59], a[68:71], a[136:139], v[56:59]
    v_mul_f32 v8, s44, v8
    v_mul_f32 v9, s44, v9
    v_mfma_f32_16x16x32_bf16 v[60:63], a[68:71], a[140:143], v[60:63]
    v_mul_f32 v10, s44, v10
    v_mul_f32 v11, s44, v11
    v_mfma_f32_16x16x32_bf16 v[96:99], a[24:27], a[112:115], v[96:99]
    v_mul_f32 v12, s44, v12
    v_mul_f32 v13, s44, v13
    v_mfma_f32_16x16x32_bf16 v[100:103], a[24:27], a[116:119], v[100:103]
    v_mul_f32 v14, s44, v14
    v_mul_f32 v15, s44, v15
    v_mfma_f32_16x16x32_bf16 v[104:107], a[24:27], a[120:123], v[104:107]
    v_mul_f32 v48, v32, v48
    v_mul_f32 v49, v33, v49
    v_mfma_f32_16x16x32_bf16 v[108:111], a[24:27], a[124:127], v[108:111]
    v_mul_f32 v50, v34, v50
    v_mul_f32 v51, v35, v51
    v_mfma_f32_16x16x32_bf16 v[112:115], a[28:31], a[112:115], v[112:115]
    v_mul_f32 v52, v36, v52
    v_mul_f32 v53, v37, v53
    v_mfma_f32_16x16x32_bf16 v[116:119], a[28:31], a[116:119], v[116:119]
    v_mul_f32 v54, v38, v54
    v_mul_f32 v55, v39, v55
    v_mfma_f32_16x16x32_bf16 v[120:123], a[28:31], a[120:123], v[120:123]
    v_mul_f32 v32, s44, v32
    v_mul_f32 v33, s44, v33
    v_mfma_f32_16x16x32_bf16 v[124:127], a[28:31], a[124:127], v[124:127]
    s_waitcnt lgkmcnt(15)
    v_mul_f32 v34, s44, v34
    v_mul_f32 v35, s44, v35
    v_mfma_f32_16x16x32_bf16 v[64:67], a[72:75], a[128:131], v[64:67]
    v_mul_f32 v36, s44, v36
    v_mul_f32 v37, s44, v37
    v_mfma_f32_16x16x32_bf16 v[68:71], a[72:75], a[132:135], v[68:71]
    v_mul_f32 v38, s44, v38
    v_mul_f32 v39, s44, v39
    v_mfma_f32_16x16x32_bf16 v[72:75], a[72:75], a[136:139], v[72:75]
    v_mul_f32 v56, v40, v56
    v_mul_f32 v57, v41, v57
    v_mfma_f32_16x16x32_bf16 v[76:79], a[72:75], a[140:143], v[76:79]
    v_mul_f32 v58, v42, v58
    v_mul_f32 v59, v43, v59
    v_mfma_f32_16x16x32_bf16 v[80:83], a[76:79], a[128:131], v[80:83]
    v_mul_f32 v60, v44, v60
    v_mul_f32 v61, v45, v61
    v_mfma_f32_16x16x32_bf16 v[84:87], a[76:79], a[132:135], v[84:87]
    v_mul_f32 v62, v46, v62
    v_mul_f32 v63, v47, v63
    v_mfma_f32_16x16x32_bf16 v[88:91], a[76:79], a[136:139], v[88:91]
    v_mul_f32 v40, s44, v40
    v_mul_f32 v41, s44, v41
    v_mfma_f32_16x16x32_bf16 v[92:95], a[76:79], a[140:143], v[92:95]
    v_mul_f32 v42, s44, v42
    v_mul_f32 v43, s44, v43
    v_mfma_f32_16x16x32_bf16 v[128:131], a[32:35], a[112:115], v[128:131]
    v_mul_f32 v44, s44, v44
    v_mul_f32 v45, s44, v45
    v_mfma_f32_16x16x32_bf16 v[132:135], a[32:35], a[116:119], v[132:135]
    v_mul_f32 v46, s44, v46
    v_mul_f32 v47, s44, v47
    v_mfma_f32_16x16x32_bf16 v[136:139], a[32:35], a[120:123], v[136:139]
    v_mul_f32 v80, v64, v80
    v_mul_f32 v81, v65, v81
    v_mfma_f32_16x16x32_bf16 v[140:143], a[32:35], a[124:127], v[140:143]
    v_mul_f32 v82, v66, v82
    v_mul_f32 v83, v67, v83
    v_mfma_f32_16x16x32_bf16 v[144:147], a[36:39], a[112:115], v[144:147]
    v_mul_f32 v84, v68, v84
    v_mul_f32 v85, v69, v85
    v_mfma_f32_16x16x32_bf16 v[148:151], a[36:39], a[116:119], v[148:151]
    v_mul_f32 v86, v70, v86
    v_mul_f32 v87, v71, v87
    v_mfma_f32_16x16x32_bf16 v[152:155], a[36:39], a[120:123], v[152:155]
    v_mul_f32 v64, s44, v64
    v_mul_f32 v65, s44, v65
    v_mfma_f32_16x16x32_bf16 v[156:159], a[36:39], a[124:127], v[156:159]
    s_waitcnt lgkmcnt(12)
    v_mul_f32 v66, s44, v66
    v_mul_f32 v67, s44, v67
    v_mfma_f32_16x16x32_bf16 v[96:99], a[80:83], a[128:131], v[96:99]
    v_mul_f32 v68, s44, v68
    v_mul_f32 v69, s44, v69
    v_mfma_f32_16x16x32_bf16 v[100:103], a[80:83], a[132:135], v[100:103]
    v_mul_f32 v70, s44, v70
    v_mul_f32 v71, s44, v71
    v_mfma_f32_16x16x32_bf16 v[104:107], a[80:83], a[136:139], v[104:107]
    v_mul_f32 v88, v72, v88
    v_mul_f32 v89, v73, v89
    v_mfma_f32_16x16x32_bf16 v[108:111], a[80:83], a[140:143], v[108:111]
    v_mul_f32 v90, v74, v90
    v_mul_f32 v91, v75, v91
    v_mfma_f32_16x16x32_bf16 v[112:115], a[84:87], a[128:131], v[112:115]
    v_mul_f32 v92, v76, v92
    v_mul_f32 v93, v77, v93
    v_mfma_f32_16x16x32_bf16 v[116:119], a[84:87], a[132:135], v[116:119]
    v_mul_f32 v94, v78, v94
    v_mul_f32 v95, v79, v95
    v_mfma_f32_16x16x32_bf16 v[120:123], a[84:87], a[136:139], v[120:123]
    v_mul_f32 v72, s44, v72
    v_mul_f32 v73, s44, v73
    v_mfma_f32_16x16x32_bf16 v[124:127], a[84:87], a[140:143], v[124:127]
    v_mul_f32 v74, s44, v74
    v_mul_f32 v75, s44, v75
    v_mfma_f32_16x16x32_bf16 v[160:163], a[40:43], a[112:115], v[160:163]
    v_mul_f32 v76, s44, v76
    v_mul_f32 v77, s44, v77
    v_mfma_f32_16x16x32_bf16 v[164:167], a[40:43], a[116:119], v[164:167]
    v_mul_f32 v78, s44, v78
    v_mul_f32 v79, s44, v79
    v_mfma_f32_16x16x32_bf16 v[168:171], a[40:43], a[120:123], v[168:171]
    v_mul_f32 v112, v96, v112
    v_mul_f32 v113, v97, v113
    v_mfma_f32_16x16x32_bf16 v[172:175], a[40:43], a[124:127], v[172:175]
    v_mul_f32 v114, v98, v114
    v_mul_f32 v115, v99, v115
    v_mfma_f32_16x16x32_bf16 v[176:179], a[44:47], a[112:115], v[176:179]
    v_mul_f32 v116, v100, v116
    v_mul_f32 v117, v101, v117
    v_mfma_f32_16x16x32_bf16 v[180:183], a[44:47], a[116:119], v[180:183]
    v_mul_f32 v118, v102, v118
    v_mul_f32 v119, v103, v119
    v_mfma_f32_16x16x32_bf16 v[184:187], a[44:47], a[120:123], v[184:187]
    v_mul_f32 v96, s44, v96
    v_mul_f32 v97, s44, v97
    v_mfma_f32_16x16x32_bf16 v[188:191], a[44:47], a[124:127], v[188:191]
    s_waitcnt lgkmcnt(8)
    v_mul_f32 v98, s44, v98
    v_mul_f32 v99, s44, v99
    v_mfma_f32_16x16x32_bf16 v[128:131], a[88:91], a[128:131], v[128:131]
    v_mul_f32 v100, s44, v100
    v_mul_f32 v101, s44, v101
    v_mfma_f32_16x16x32_bf16 v[132:135], a[88:91], a[132:135], v[132:135]
    v_mul_f32 v102, s44, v102
    v_mul_f32 v103, s44, v103
    v_mfma_f32_16x16x32_bf16 v[136:139], a[88:91], a[136:139], v[136:139]
    v_mul_f32 v120, v104, v120
    v_mul_f32 v121, v105, v121
    v_mfma_f32_16x16x32_bf16 v[140:143], a[88:91], a[140:143], v[140:143]
    v_mul_f32 v122, v106, v122
    v_mul_f32 v123, v107, v123
    v_mfma_f32_16x16x32_bf16 v[144:147], a[92:95], a[128:131], v[144:147]
    v_mul_f32 v124, v108, v124
    v_mul_f32 v125, v109, v125
    v_mfma_f32_16x16x32_bf16 v[148:151], a[92:95], a[132:135], v[148:151]
    v_mul_f32 v126, v110, v126
    v_mul_f32 v127, v111, v127
    v_mfma_f32_16x16x32_bf16 v[152:155], a[92:95], a[136:139], v[152:155]
    v_mul_f32 v104, s44, v104
    v_mul_f32 v105, s44, v105
    v_mfma_f32_16x16x32_bf16 v[156:159], a[92:95], a[140:143], v[156:159]
    v_mul_f32 v106, s44, v106
    v_mul_f32 v107, s44, v107
    v_mfma_f32_16x16x32_bf16 v[192:195], a[48:51], a[112:115], v[192:195]
    v_mul_f32 v108, s44, v108
    v_mul_f32 v109, s44, v109
    v_mfma_f32_16x16x32_bf16 v[196:199], a[48:51], a[116:119], v[196:199]
    v_mul_f32 v110, s44, v110
    v_mul_f32 v111, s44, v111
    v_mfma_f32_16x16x32_bf16 v[200:203], a[48:51], a[120:123], v[200:203]
    v_mul_f32 v144, v128, v144
    v_mul_f32 v145, v129, v145
    v_mfma_f32_16x16x32_bf16 v[204:207], a[48:51], a[124:127], v[204:207]
    v_mul_f32 v146, v130, v146
    v_mul_f32 v147, v131, v147
    v_mfma_f32_16x16x32_bf16 v[208:211], a[52:55], a[112:115], v[208:211]
    v_mul_f32 v148, v132, v148
    v_mul_f32 v149, v133, v149
    v_mfma_f32_16x16x32_bf16 v[212:215], a[52:55], a[116:119], v[212:215]
    v_mul_f32 v150, v134, v150
    v_mul_f32 v151, v135, v151
    v_mfma_f32_16x16x32_bf16 v[216:219], a[52:55], a[120:123], v[216:219]
    v_mul_f32 v128, s44, v128
    v_mul_f32 v129, s44, v129
    v_mfma_f32_16x16x32_bf16 v[220:223], a[52:55], a[124:127], v[220:223]
    s_waitcnt lgkmcnt(4)
    v_mul_f32 v130, s44, v130
    v_mul_f32 v131, s44, v131
    v_mfma_f32_16x16x32_bf16 v[160:163], a[96:99], a[128:131], v[160:163]
    v_mul_f32 v132, s44, v132
    v_mul_f32 v133, s44, v133
    v_mfma_f32_16x16x32_bf16 v[164:167], a[96:99], a[132:135], v[164:167]
    v_mul_f32 v134, s44, v134
    v_mul_f32 v135, s44, v135
    v_mfma_f32_16x16x32_bf16 v[168:171], a[96:99], a[136:139], v[168:171]
    v_mul_f32 v152, v136, v152
    v_mul_f32 v153, v137, v153
    v_mfma_f32_16x16x32_bf16 v[172:175], a[96:99], a[140:143], v[172:175]
    v_mul_f32 v154, v138, v154
    v_mul_f32 v155, v139, v155
    v_mfma_f32_16x16x32_bf16 v[176:179], a[100:103], a[128:131], v[176:179]
    v_mul_f32 v156, v140, v156
    v_mul_f32 v157, v141, v157
    v_mfma_f32_16x16x32_bf16 v[180:183], a[100:103], a[132:135], v[180:183]
    v_mul_f32 v158, v142, v158
    v_mul_f32 v159, v143, v159
    v_mfma_f32_16x16x32_bf16 v[184:187], a[100:103], a[136:139], v[184:187]
    v_mul_f32 v136, s44, v136
    v_mul_f32 v137, s44, v137
    v_mfma_f32_16x16x32_bf16 v[188:191], a[100:103], a[140:143], v[188:191]
    s_waitcnt lgkmcnt(0)
    v_mul_f32 v138, s44, v138
    v_mul_f32 v139, s44, v139
    v_mfma_f32_16x16x32_bf16 v[192:195], a[104:107], a[128:131], v[192:195]
    v_mul_f32 v140, s44, v140
    v_mul_f32 v141, s44, v141
    v_mfma_f32_16x16x32_bf16 v[196:199], a[104:107], a[132:135], v[196:199]
    v_mul_f32 v142, s44, v142
    v_mul_f32 v143, s44, v143
    v_mfma_f32_16x16x32_bf16 v[200:203], a[104:107], a[136:139], v[200:203]
    v_mfma_f32_16x16x32_bf16 v[204:207], a[104:107], a[140:143], v[204:207]
    v_mfma_f32_16x16x32_bf16 v[208:211], a[108:111], a[128:131], v[208:211]
    v_mfma_f32_16x16x32_bf16 v[212:215], a[108:111], a[132:135], v[212:215]
    v_mfma_f32_16x16x32_bf16 v[216:219], a[108:111], a[136:139], v[216:219]
    v_mfma_f32_16x16x32_bf16 v[220:223], a[108:111], a[140:143], v[220:223]
    s_getpc_b64 s[10:11]
L_pcb:
    s_lshl_b32 s8, s48, 2
    s_add_u32 s8, s8, s32
    s_lshl_b32 s8, s8, 6
    s_add_u32 s8, s8, L_hgo - L_pcb
    s_add_u32 s10, s10, s8
    s_addc_u32 s11, s11, 0
    s_load_dword s63, s[10:11], 0
    s_load_dword s63, s[10:11], 8192
    v_exp_f32 v0, v0
    v_exp_f32 v1, v1
    v_exp_f32 v2, v2
    v_exp_f32 v3, v3
    v_exp_f32 v4, v4
    v_exp_f32 v5, v5
    v_exp_f32 v6, v6
    v_exp_f32 v7, v7
    v_pk_add_f32 v[0:1], v[0:1], s[18:19]
    v_pk_add_f32 v[2:3], v[2:3], s[18:19]
    v_pk_add_f32 v[4:5], v[4:5], s[18:19]
    v_pk_add_f32 v[6:7], v[6:7], s[18:19]
    v_rcp_f32 v0, v0
    v_rcp_f32 v1, v1
    v_rcp_f32 v2, v2
    v_rcp_f32 v3, v3
    v_rcp_f32 v4, v4
    v_rcp_f32 v5, v5
    v_rcp_f32 v6, v6
    v_rcp_f32 v7, v7
    v_pk_mul_f32 v[16:17], v[0:1], v[16:17]
    v_pk_mul_f32 v[18:19], v[2:3], v[18:19]
    v_pk_mul_f32 v[20:21], v[4:5], v[20:21]
    v_pk_mul_f32 v[22:23], v[6:7], v[22:23]
    v_cvt_pk_bf16_f32 v0, v16, v17
    v_cvt_pk_bf16_f32 v1, v18, v19
    v_cvt_pk_bf16_f32 v2, v20, v21
    v_cvt_pk_bf16_f32 v3, v22, v23
    s_mov_b32 s39, 0
    s_nop 0
    v_permlane16_swap_b32 v0, v2
    v_permlane16_swap_b32 v1, v3
    buffer_store_dwordx4 v[0:3], v232, s[28:31], s39 offen offset:0 sc1
    v_exp_f32 v8, v8
    v_exp_f32 v9, v9
    v_exp_f32 v10, v10
    v_exp_f32 v11, v11
    v_exp_f32 v12, v12
    v_exp_f32 v13, v13
    v_exp_f32 v14, v14
    v_exp_f32 v15, v15
    v_pk_add_f32 v[8:9], v[8:9], s[18:19]
    v_pk_add_f32 v[10:11], v[10:11], s[18:19]
    v_pk_add_f32 v[12:13], v[12:13], s[18:19]
    v_pk_add_f32 v[14:15], v[14:15], s[18:19]
    v_rcp_f32 v8, v8
    v_rcp_f32 v9, v9
    v_rcp_f32 v10, v10
    v_rcp_f32 v11, v11
    v_rcp_f32 v12, v12
    v_rcp_f32 v13, v13
    v_rcp_f32 v14, v14
    v_rcp_f32 v15, v15
    v_pk_mul_f32 v[24:25], v[8:9], v[24:25]
    v_pk_mul_f32 v[26:27], v[10:11], v[26:27]
    v_pk_mul_f32 v[28:29], v[12:13], v[28:29]
    v_pk_mul_f32 v[30:31], v[14:15], v[30:31]
    v_cvt_pk_bf16_f32 v8, v24, v25
    v_cvt_pk_bf16_f32 v9, v26, v27
    v_cvt_pk_bf16_f32 v10, v28, v29
    v_cvt_pk_bf16_f32 v11, v30, v31
    s_mov_b32 s39, 229376
    s_nop 0
    v_permlane16_swap_b32 v8, v10
    v_permlane16_swap_b32 v9, v11
    buffer_store_dwordx4 v[8:11], v232, s[28:31], s39 offen offset:0 sc1
    v_exp_f32 v32, v32
    v_exp_f32 v33, v33
    v_exp_f32 v34, v34
    v_exp_f32 v35, v35
    v_exp_f32 v36, v36
    v_exp_f32 v37, v37
    v_exp_f32 v38, v38
    v_exp_f32 v39, v39
    v_pk_add_f32 v[32:33], v[32:33], s[18:19]
    v_pk_add_f32 v[34:35], v[34:35], s[18:19]
    v_pk_add_f32 v[36:37], v[36:37], s[18:19]
    v_pk_add_f32 v[38:39], v[38:39], s[18:19]
    v_rcp_f32 v32, v32
    v_rcp_f32 v33, v33
    v_rcp_f32 v34, v34
    v_rcp_f32 v35, v35
    v_rcp_f32 v36, v36
    v_rcp_f32 v37, v37
    v_rcp_f32 v38, v38
    v_rcp_f32 v39, v39
    v_pk_mul_f32 v[48:49], v[32:33], v[48:49]
    v_pk_mul_f32 v[50:51], v[34:35], v[50:51]
    v_pk_mul_f32 v[52:53], v[36:37], v[52:53]
    v_pk_mul_f32 v[54:55], v[38:39], v[54:55]
    v_cvt_pk_bf16_f32 v32, v48, v49
    v_cvt_pk_bf16_f32 v33, v50, v51
    v_cvt_pk_bf16_f32 v34, v52, v53
    v_cvt_pk_bf16_f32 v35, v54, v55
    s_mov_b32 s39, 0
    s_nop 0
    v_permlane16_swap_b32 v32, v34
    v_permlane16_swap_b32 v33, v35
    buffer_store_dwordx4 v[32:35], v232, s[28:31], s39 offen offset:1024 sc1
    v_exp_f32 v40, v40
    v_exp_f32 v41, v41
    v_exp_f32 v42, v42
    v_exp_f32 v43, v43
    v_exp_f32 v44, v44
    v_exp_f32 v45, v45
    v_exp_f32 v46, v46
    v_exp_f32 v47, v47
    v_pk_add_f32 v[40:41], v[40:41], s[18:19]
    v_pk_add_f32 v[42:43], v[42:43], s[18:19]
    v_pk_add_f32 v[44:45], v[44:45], s[18:19]
    v_pk_add_f32 v[46:47], v[46:47], s[18:19]
    v_rcp_f32 v40, v40
    v_rcp_f32 v41, v41
    v_rcp_f32 v42, v42
    v_rcp_f32 v43, v43
    v_rcp_f32 v44, v44
    v_rcp_f32 v45, v45
    v_rcp_f32 v46, v46
    v_rcp_f32 v47, v47
    v_pk_mul_f32 v[56:57], v[40:41], v[56:57]
    v_pk_mul_f32 v[58:59], v[42:43], v[58:59]
    v_pk_mul_f32 v[60:61], v[44:45], v[60:61]
    v_pk_mul_f32 v[62:63], v[46:47], v[62:63]
    v_cvt_pk_bf16_f32 v40, v56, v57
    v_cvt_pk_bf16_f32 v41, v58, v59
    v_cvt_pk_bf16_f32 v42, v60, v61
    v_cvt_pk_bf16_f32 v43, v62, v63
    s_mov_b32 s39, 229376
    s_nop 0
    v_permlane16_swap_b32 v40, v42
    v_permlane16_swap_b32 v41, v43
    buffer_store_dwordx4 v[40:43], v232, s[28:31], s39 offen offset:1024 sc1
    v_exp_f32 v64, v64
    v_exp_f32 v65, v65
    v_exp_f32 v66, v66
    v_exp_f32 v67, v67
    v_exp_f32 v68, v68
    v_exp_f32 v69, v69
    v_exp_f32 v70, v70
    v_exp_f32 v71, v71
    v_pk_add_f32 v[64:65], v[64:65], s[18:19]
    v_pk_add_f32 v[66:67], v[66:67], s[18:19]
    v_pk_add_f32 v[68:69], v[68:69], s[18:19]
    v_pk_add_f32 v[70:71], v[70:71], s[18:19]
    v_rcp_f32 v64, v64
    v_rcp_f32 v65, v65
    v_rcp_f32 v66, v66
    v_rcp_f32 v67, v67
    v_rcp_f32 v68, v68
    v_rcp_f32 v69, v69
    v_rcp_f32 v70, v70
    v_rcp_f32 v71, v71
    v_pk_mul_f32 v[80:81], v[64:65], v[80:81]
    v_pk_mul_f32 v[82:83], v[66:67], v[82:83]
    v_pk_mul_f32 v[84:85], v[68:69], v[84:85]
    v_pk_mul_f32 v[86:87], v[70:71], v[86:87]
    v_cvt_pk_bf16_f32 v64, v80, v81
    v_cvt_pk_bf16_f32 v65, v82, v83
    v_cvt_pk_bf16_f32 v66, v84, v85
    v_cvt_pk_bf16_f32 v67, v86, v87
    s_mov_b32 s39, 0
    s_nop 0
    v_permlane16_swap_b32 v64, v66
    v_permlane16_swap_b32 v65, v67
    buffer_store_dwordx4 v[64:67], v232, s[28:31], s39 offen offset:2048 sc1
    v_exp_f32 v72, v72
    v_exp_f32 v73, v73
    v_exp_f32 v74, v74
    v_exp_f32 v75, v75
    v_exp_f32 v76, v76
    v_exp_f32 v77, v77
    v_exp_f32 v78, v78
    v_exp_f32 v79, v79
    v_pk_add_f32 v[72:73], v[72:73], s[18:19]
    v_pk_add_f32 v[74:75], v[74:75], s[18:19]
    v_pk_add_f32 v[76:77], v[76:77], s[18:19]
    v_pk_add_f32 v[78:79], v[78:79], s[18:19]
    v_rcp_f32 v72, v72
    v_rcp_f32 v73, v73
    v_rcp_f32 v74, v74
    v_rcp_f32 v75, v75
    v_rcp_f32 v76, v76
    v_rcp_f32 v77, v77
    v_rcp_f32 v78, v78
    v_rcp_f32 v79, v79
    v_pk_mul_f32 v[88:89], v[72:73], v[88:89]
    v_pk_mul_f32 v[90:91], v[74:75], v[90:91]
    v_pk_mul_f32 v[92:93], v[76:77], v[92:93]
    v_pk_mul_f32 v[94:95], v[78:79], v[94:95]
    v_cvt_pk_bf16_f32 v72, v88, v89
    v_cvt_pk_bf16_f32 v73, v90, v91
    v_cvt_pk_bf16_f32 v74, v92, v93
    v_cvt_pk_bf16_f32 v75, v94, v95
    s_mov_b32 s39, 229376
    s_nop 0
    v_permlane16_swap_b32 v72, v74
    v_permlane16_swap_b32 v73, v75
    buffer_store_dwordx4 v[72:75], v232, s[28:31], s39 offen offset:2048 sc1
    v_exp_f32 v96, v96
    v_exp_f32 v97, v97
    v_exp_f32 v98, v98
    v_exp_f32 v99, v99
    v_exp_f32 v100, v100
    v_exp_f32 v101, v101
    v_exp_f32 v102, v102
    v_exp_f32 v103, v103
    v_pk_add_f32 v[96:97], v[96:97], s[18:19]
    v_pk_add_f32 v[98:99], v[98:99], s[18:19]
    v_pk_add_f32 v[100:101], v[100:101], s[18:19]
    v_pk_add_f32 v[102:103], v[102:103], s[18:19]
    v_rcp_f32 v96, v96
    v_rcp_f32 v97, v97
    v_rcp_f32 v98, v98
    v_rcp_f32 v99, v99
    v_rcp_f32 v100, v100
    v_rcp_f32 v101, v101
    v_rcp_f32 v102, v102
    v_rcp_f32 v103, v103
    v_pk_mul_f32 v[112:113], v[96:97], v[112:113]
    v_pk_mul_f32 v[114:115], v[98:99], v[114:115]
    v_pk_mul_f32 v[116:117], v[100:101], v[116:117]
    v_pk_mul_f32 v[118:119], v[102:103], v[118:119]
    v_cvt_pk_bf16_f32 v96, v112, v113
    v_cvt_pk_bf16_f32 v97, v114, v115
    v_cvt_pk_bf16_f32 v98, v116, v117
    v_cvt_pk_bf16_f32 v99, v118, v119
    s_mov_b32 s39, 0
    s_nop 0
    v_permlane16_swap_b32 v96, v98
    v_permlane16_swap_b32 v97, v99
    buffer_store_dwordx4 v[96:99], v232, s[28:31], s39 offen offset:3072 sc1
    v_exp_f32 v104, v104
    v_exp_f32 v105, v105
    v_exp_f32 v106, v106
    v_exp_f32 v107, v107
    v_exp_f32 v108, v108
    v_exp_f32 v109, v109
    v_exp_f32 v110, v110
    v_exp_f32 v111, v111
    v_pk_add_f32 v[104:105], v[104:105], s[18:19]
    v_pk_add_f32 v[106:107], v[106:107], s[18:19]
    v_pk_add_f32 v[108:109], v[108:109], s[18:19]
    v_pk_add_f32 v[110:111], v[110:111], s[18:19]
    v_rcp_f32 v104, v104
    v_rcp_f32 v105, v105
    v_rcp_f32 v106, v106
    v_rcp_f32 v107, v107
    v_rcp_f32 v108, v108
    v_rcp_f32 v109, v109
    v_rcp_f32 v110, v110
    v_rcp_f32 v111, v111
    v_pk_mul_f32 v[120:121], v[104:105], v[120:121]
    v_pk_mul_f32 v[122:123], v[106:107], v[122:123]
    v_pk_mul_f32 v[124:125], v[108:109], v[124:125]
    v_pk_mul_f32 v[126:127], v[110:111], v[126:127]
    v_cvt_pk_bf16_f32 v104, v120, v121
    v_cvt_pk_bf16_f32 v105, v122, v123
    v_cvt_pk_bf16_f32 v106, v124, v125
    v_cvt_pk_bf16_f32 v107, v126, v127
    s_mov_b32 s39, 229376
    s_nop 0
    v_permlane16_swap_b32 v104, v106
    v_permlane16_swap_b32 v105, v107
    buffer_store_dwordx4 v[104:107], v232, s[28:31], s39 offen offset:3072 sc1
    v_exp_f32 v128, v128
    v_exp_f32 v129, v129
    v_exp_f32 v130, v130
    v_exp_f32 v131, v131
    v_exp_f32 v132, v132
    v_exp_f32 v133, v133
    v_exp_f32 v134, v134
    v_exp_f32 v135, v135
    v_pk_add_f32 v[128:129], v[128:129], s[18:19]
    v_pk_add_f32 v[130:131], v[130:131], s[18:19]
    v_pk_add_f32 v[132:133], v[132:133], s[18:19]
    v_pk_add_f32 v[134:135], v[134:135], s[18:19]
    v_rcp_f32 v128, v128
    v_rcp_f32 v129, v129
    v_rcp_f32 v130, v130
    v_rcp_f32 v131, v131
    v_rcp_f32 v132, v132
    v_rcp_f32 v133, v133
    v_rcp_f32 v134, v134
    v_rcp_f32 v135, v135
    v_pk_mul_f32 v[144:145], v[128:129], v[144:145]
    v_pk_mul_f32 v[146:147], v[130:131], v[146:147]
    v_pk_mul_f32 v[148:149], v[132:133], v[148:149]
    v_pk_mul_f32 v[150:151], v[134:135], v[150:151]
    v_cvt_pk_bf16_f32 v128, v144, v145
    v_cvt_pk_bf16_f32 v129, v146, v147
    v_cvt_pk_bf16_f32 v130, v148, v149
    v_cvt_pk_bf16_f32 v131, v150, v151
    s_mov_b32 s39, 4096
    s_nop 0
    v_permlane16_swap_b32 v128, v130
    v_permlane16_swap_b32 v129, v131
    buffer_store_dwordx4 v[128:131], v232, s[28:31], s39 offen offset:0 sc1
    v_exp_f32 v136, v136
    v_exp_f32 v137, v137
    v_exp_f32 v138, v138
    v_exp_f32 v139, v139
    v_exp_f32 v140, v140
    v_exp_f32 v141, v141
    v_exp_f32 v142, v142
    v_exp_f32 v143, v143
    v_pk_add_f32 v[136:137], v[136:137], s[18:19]
    v_pk_add_f32 v[138:139], v[138:139], s[18:19]
    v_pk_add_f32 v[140:141], v[140:141], s[18:19]
    v_pk_add_f32 v[142:143], v[142:143], s[18:19]
    v_rcp_f32 v136, v136
    v_rcp_f32 v137, v137
    v_rcp_f32 v138, v138
    v_rcp_f32 v139, v139
    v_rcp_f32 v140, v140
    v_rcp_f32 v141, v141
    v_rcp_f32 v142, v142
    v_rcp_f32 v143, v143
    v_pk_mul_f32 v[152:153], v[136:137], v[152:153]
    v_pk_mul_f32 v[154:155], v[138:139], v[154:155]
    v_pk_mul_f32 v[156:157], v[140:141], v[156:157]
    v_pk_mul_f32 v[158:159], v[142:143], v[158:159]
    v_cvt_pk_bf16_f32 v136, v152, v153
    v_cvt_pk_bf16_f32 v137, v154, v155
    v_cvt_pk_bf16_f32 v138, v156, v157
    v_cvt_pk_bf16_f32 v139, v158, v159
    s_mov_b32 s39, 233472
    s_nop 0
    v_permlane16_swap_b32 v136, v138
    v_permlane16_swap_b32 v137, v139
    buffer_store_dwordx4 v[136:139], v232, s[28:31], s39 offen offset:0 sc1
    v_pk_mul_f32 v[176:177], v[160:161], v[176:177]
    v_pk_mul_f32 v[178:179], v[162:163], v[178:179]
    v_pk_mul_f32 v[180:181], v[164:165], v[180:181]
    v_pk_mul_f32 v[182:183], v[166:167], v[182:183]
    v_pk_mul_f32 v[160:161], v[160:161], s[44:45]
    v_pk_mul_f32 v[162:163], v[162:163], s[44:45]
    v_pk_mul_f32 v[164:165], v[164:165], s[44:45]
    v_pk_mul_f32 v[166:167], v[166:167], s[44:45]
    v_exp_f32 v160, v160
    v_exp_f32 v161, v161
    v_exp_f32 v162, v162
    v_exp_f32 v163, v163
    v_exp_f32 v164, v164
    v_exp_f32 v165, v165
    v_exp_f32 v166, v166
    v_exp_f32 v167, v167
    v_pk_add_f32 v[160:161], v[160:161], s[18:19]
    v_pk_add_f32 v[162:163], v[162:163], s[18:19]
    v_pk_add_f32 v[164:165], v[164:165], s[18:19]
    v_pk_add_f32 v[166:167], v[166:167], s[18:19]
    v_rcp_f32 v160, v160
    v_rcp_f32 v161, v161
    v_rcp_f32 v162, v162
    v_rcp_f32 v163, v163
    v_rcp_f32 v164, v164
    v_rcp_f32 v165, v165
    v_rcp_f32 v166, v166
    v_rcp_f32 v167, v167
    v_pk_mul_f32 v[176:177], v[160:161], v[176:177]
    v_pk_mul_f32 v[178:179], v[162:163], v[178:179]
    v_pk_mul_f32 v[180:181], v[164:165], v[180:181]
    v_pk_mul_f32 v[182:183], v[166:167], v[182:183]
    v_cvt_pk_bf16_f32 v160, v176, v177
    v_cvt_pk_bf16_f32 v161, v178, v179
    v_cvt_pk_bf16_f32 v162, v180, v181
    v_cvt_pk_bf16_f32 v163, v182, v183
    s_mov_b32 s39, 4096
    s_nop 0
    v_permlane16_swap_b32 v160, v162
    v_permlane16_swap_b32 v161, v163
    buffer_store_dwordx4 v[160:163], v232, s[28:31], s39 offen offset:1024 sc1
    v_pk_mul_f32 v[184:185], v[168:169], v[184:185]
    v_pk_mul_f32 v[186:187], v[170:171], v[186:187]
    v_pk_mul_f32 v[188:189], v[172:173], v[188:189]
    v_pk_mul_f32 v[190:191], v[174:175], v[190:191]
    v_pk_mul_f32 v[168:169], v[168:169], s[44:45]
    v_pk_mul_f32 v[170:171], v[170:171], s[44:45]
    v_pk_mul_f32 v[172:173], v[172:173], s[44:45]
    v_pk_mul_f32 v[174:175], v[174:175], s[44:45]
    v_exp_f32 v168, v168
    v_exp_f32 v169, v169
    v_exp_f32 v170, v170
    v_exp_f32 v171, v171
    v_exp_f32 v172, v172
    v_exp_f32 v173, v173
    v_exp_f32 v174, v174
    v_exp_f32 v175, v175
    v_pk_add_f32 v[168:169], v[168:169], s[18:19]
    v_pk_add_f32 v[170:171], v[170:171], s[18:19]
    v_pk_add_f32 v[172:173], v[172:173], s[18:19]
    v_pk_add_f32 v[174:175], v[174:175], s[18:19]
    v_rcp_f32 v168, v168
    v_rcp_f32 v169, v169
    v_rcp_f32 v170, v170
    v_rcp_f32 v171, v171
    v_rcp_f32 v172, v172
    v_rcp_f32 v173, v173
    v_rcp_f32 v174, v174
    v_rcp_f32 v175, v175
    v_pk_mul_f32 v[184:185], v[168:169], v[184:185]
    v_pk_mul_f32 v[186:187], v[170:171], v[186:187]
    v_pk_mul_f32 v[188:189], v[172:173], v[188:189]
    v_pk_mul_f32 v[190:191], v[174:175], v[190:191]
    v_cvt_pk_bf16_f32 v168, v184, v185
    v_cvt_pk_bf16_f32 v169, v186, v187
    v_cvt_pk_bf16_f32 v170, v188, v189
    v_cvt_pk_bf16_f32 v171, v190, v191
    s_mov_b32 s39, 233472
    s_nop 0
    v_permlane16_swap_b32 v168, v170
    v_permlane16_swap_b32 v169, v171
    buffer_store_dwordx4 v[168:171], v232, s[28:31], s39 offen offset:1024 sc1
    v_pk_mul_f32 v[208:209], v[192:193], v[208:209]
    v_pk_mul_f32 v[210:211], v[194:195], v[210:211]
    v_pk_mul_f32 v[212:213], v[196:197], v[212:213]
    v_pk_mul_f32 v[214:215], v[198:199], v[214:215]
    v_pk_mul_f32 v[192:193], v[192:193], s[44:45]
    v_pk_mul_f32 v[194:195], v[194:195], s[44:45]
    v_pk_mul_f32 v[196:197], v[196:197], s[44:45]
    v_pk_mul_f32 v[198:199], v[198:199], s[44:45]
    v_exp_f32 v192, v192
    v_exp_f32 v193, v193
    v_exp_f32 v194, v194
    v_exp_f32 v195, v195
    v_exp_f32 v196, v196
    v_exp_f32 v197, v197
    v_exp_f32 v198, v198
    v_exp_f32 v199, v199
    v_pk_add_f32 v[192:193], v[192:193], s[18:19]
    v_pk_add_f32 v[194:195], v[194:195], s[18:19]
    v_pk_add_f32 v[196:197], v[196:197], s[18:19]
    v_pk_add_f32 v[198:199], v[198:199], s[18:19]
    v_rcp_f32 v192, v192
    v_rcp_f32 v193, v193
    v_rcp_f32 v194, v194
    v_rcp_f32 v195, v195
    v_rcp_f32 v196, v196
    v_rcp_f32 v197, v197
    v_rcp_f32 v198, v198
    v_rcp_f32 v199, v199
    v_pk_mul_f32 v[208:209], v[192:193], v[208:209]
    v_pk_mul_f32 v[210:211], v[194:195], v[210:211]
    v_pk_mul_f32 v[212:213], v[196:197], v[212:213]
    v_pk_mul_f32 v[214:215], v[198:199], v[214:215]
    v_cvt_pk_bf16_f32 v192, v208, v209
    v_cvt_pk_bf16_f32 v193, v210, v211
    v_cvt_pk_bf16_f32 v194, v212, v213
    v_cvt_pk_bf16_f32 v195, v214, v215
    s_mov_b32 s39, 4096
    s_nop 0
    v_permlane16_swap_b32 v192, v194
    v_permlane16_swap_b32 v193, v195
    buffer_store_dwordx4 v[192:195], v232, s[28:31], s39 offen offset:2048 sc1
    v_pk_mul_f32 v[216:217], v[200:201], v[216:217]
    v_pk_mul_f32 v[218:219], v[202:203], v[218:219]
    v_pk_mul_f32 v[220:221], v[204:205], v[220:221]
    v_pk_mul_f32 v[222:223], v[206:207], v[222:223]
    v_pk_mul_f32 v[200:201], v[200:201], s[44:45]
    v_pk_mul_f32 v[202:203], v[202:203], s[44:45]
    v_pk_mul_f32 v[204:205], v[204:205], s[44:45]
    v_pk_mul_f32 v[206:207], v[206:207], s[44:45]
    v_exp_f32 v200, v200
    v_exp_f32 v201, v201
    v_exp_f32 v202, v202
    v_exp_f32 v203, v203
    v_exp_f32 v204, v204
    v_exp_f32 v205, v205
    v_exp_f32 v206, v206
    v_exp_f32 v207, v207
    v_pk_add_f32 v[200:201], v[200:201], s[18:19]
    v_pk_add_f32 v[202:203], v[202:203], s[18:19]
    v_pk_add_f32 v[204:205], v[204:205], s[18:19]
    v_pk_add_f32 v[206:207], v[206:207], s[18:19]
    v_rcp_f32 v200, v200
    v_rcp_f32 v201, v201
    v_rcp_f32 v202, v202
    v_rcp_f32 v203, v203
    v_rcp_f32 v204, v204
    v_rcp_f32 v205, v205
    v_rcp_f32 v206, v206
    v_rcp_f32 v207, v207
    v_pk_mul_f32 v[216:217], v[200:201], v[216:217]
    v_pk_mul_f32 v[218:219], v[202:203], v[218:219]
    v_pk_mul_f32 v[220:221], v[204:205], v[220:221]
    v_pk_mul_f32 v[222:223], v[206:207], v[222:223]
    v_cvt_pk_bf16_f32 v200, v216, v217
    v_cvt_pk_bf16_f32 v201, v218, v219
    v_cvt_pk_bf16_f32 v202, v220, v221
    v_cvt_pk_bf16_f32 v203, v222, v223
    s_mov_b32 s39, 233472
    s_nop 0
    v_permlane16_swap_b32 v200, v202
    v_permlane16_swap_b32 v201, v203
    buffer_store_dwordx4 v[200:203], v232, s[28:31], s39 offen offset:2048 sc1
    buffer_load_dword v238, v237, s[28:31], 0 offen sc1
    s_lshl_b32 s7, s32, 15
    v_subrev_u32 v128, s7, v224
    v_subrev_u32 v129, s7, v225
    v_subrev_u32 v130, s7, v226
    v_subrev_u32 v131, s7, v227
    v_and_b32 v152, 15, v251
    v_bfe_u32 v153, v251, 4, 1
    v_lshl_add_u32 v152, v153, 5, v152
    v_lshlrev_b32 v152, 4, v152
    v_lshrrev_b32 v153, 5, v251
    v_lshl_add_u32 v148, v153, 10, v152
    s_lshl_b32 s35, s32, 12
    s_lshl_b32 s37, s5, 2
    s_add_u32 s37, s37, s32
    s_mul_i32 s7, s37, 229376
    s_mul_i32 s8, s4, 114688
    s_add_u32 s7, s7, s8
    s_add_u32 s24, s16, s7
    s_addc_u32 s25, s17, 0
    s_and_b32 s25, s25, 0xffff
    s_mov_b32 s26, 114688
    s_mov_b32 s27, 0x00020000
    v_lshrrev_b32 v153, 4, v251
    v_bfe_u32 v152, v251, 2, 3
    s_lshl_b32 s7, s4, 2
    s_xor_b32 s7, s7, 4
    v_xor_b32 v152, s7, v152
    v_bfe_u32 v154, v251, 2, 2
    v_lshl_add_u32 v154, v153, 3, v154
    v_lshlrev_b32 v154, 8, v154
    v_and_b32 v155, 3, v251
    v_lshl_add_u32 v154, v155, 3, v154
    v_xor_b32 v155, 0, v152
    v_lshl_add_u32 v132, v155, 5, v154
    v_add_u32 v140, 98304, v132
    v_xor_b32 v155, 1, v152
    v_lshl_add_u32 v133, v155, 5, v154
    v_add_u32 v141, 98304, v133
    v_xor_b32 v155, 2, v152
    v_lshl_add_u32 v134, v155, 5, v154
    v_add_u32 v142, 98304, v134
    v_xor_b32 v155, 3, v152
    v_lshl_add_u32 v135, v155, 5, v154
    v_add_u32 v143, 98304, v135
    v_xor_b32 v155, 4, v152
    v_lshl_add_u32 v136, v155, 5, v154
    v_add_u32 v144, 98304, v136
    v_xor_b32 v155, 5, v152
    v_lshl_add_u32 v137, v155, 5, v154
    v_add_u32 v145, 98304, v137
    v_xor_b32 v155, 6, v152
    v_lshl_add_u32 v138, v155, 5, v154
    v_add_u32 v146, 98304, v138
    v_xor_b32 v155, 7, v152
    v_lshl_add_u32 v139, v155, 5, v154
    v_add_u32 v147, 98304, v139
    s_lshr_b32 s7, s50, 4
    s_lshl_b32 s8, s51, 1
    s_add_u32 s7, s7, s8
    s_lshl_b32 s7, s7, 7
    s_and_b32 s8, s50, 15
    s_lshl_b32 s8, s8, 2
    s_add_u32 s7, s7, s8
    s_add_u32 s7, s7, 33554432
    v_mov_b32 v157, s7
    v_mov_b32 v153, 65760
    s_mov_b32 s38, 0
    s_mov_b32 s9, 0x40000
    s_waitcnt vmcnt(1)
L_tok:
    v_readfirstlane_b32 s36, v254
    s_nop 0
    s_cmp_lg_u32 s36, 0
    s_cbranch_scc1 L_tok_ok
    s_sleep 2
    buffer_load_dword v254, v253, s[52:55], 0 offen sc1
    s_waitcnt vmcnt(0)
    s_sub_u32 s9, s9, 1
    s_cbranch_scc0 L_tok
L_tok_ok:
    s_mov_b32 s9, 0x40000
    v_mov_b32 v151, s36
    s_mov_b64 exec, 1
    buffer_store_dword v151, v157, s[28:31], 0 offen sc1
    s_mov_b64 exec, -1
    s_barrier
    ds_read_b64_tr_b16 v[64:65], v140 offset:0
    ds_read_b64_tr_b16 v[66:67], v140 offset:1024
    ds_read_b64_tr_b16 v[68:69], v141 offset:0
    ds_read_b64_tr_b16 v[70:71], v141 offset:1024
    ds_read_b64_tr_b16 v[72:73], v142 offset:0
    ds_read_b64_tr_b16 v[74:75], v142 offset:1024
    ds_read_b64_tr_b16 v[76:77], v143 offset:0
    ds_read_b64_tr_b16 v[78:79], v143 offset:1024
    ds_read_b64_tr_b16 v[80:81], v144 offset:0
    ds_read_b64_tr_b16 v[82:83], v144 offset:1024
    ds_read_b64_tr_b16 v[84:85], v145 offset:0
    ds_read_b64_tr_b16 v[86:87], v145 offset:1024
    ds_read_b64_tr_b16 v[88:89], v146 offset:0
    ds_read_b64_tr_b16 v[90:91], v146 offset:1024
    ds_read_b64_tr_b16 v[92:93], v147 offset:0
    ds_read_b64_tr_b16 v[94:95], v147 offset:1024
    s_add_u32 m0, s40, 0
    s_add_u32 s41, s58, 524288
    s_nop 0
    buffer_load_dwordx4 v224, s[20:23], s41 offen offset:0 lds
    buffer_load_dwordx4 v225, s[20:23], s41 offen offset:1024 lds
    buffer_load_dwordx4 v226, s[20:23], s41 offen offset:2048 lds
    buffer_load_dwordx4 v227, s[20:23], s41 offen offset:3072 lds
    s_add_u32 m0, s40, 4096
    s_nop 0
    buffer_load_dwordx4 v228, s[20:23], s41 offen offset:0 lds
    buffer_load_dwordx4 v229, s[20:23], s41 offen offset:1024 lds
    buffer_load_dwordx4 v230, s[20:23], s41 offen offset:2048 lds
    buffer_load_dwordx4 v231, s[20:23], s41 offen offset:3072 lds
    s_lshr_b32 s7, s32, 1
    s_add_u32 s7, s7, s57
    s_cmp_eq_u32 s7, 4
    s_cbranch_scc0 L_nowrap
    v_subrev_u32 v224, 131072, v224
    v_subrev_u32 v225, 131072, v225
    v_subrev_u32 v226, 131072, v226
    v_subrev_u32 v227, 131072, v227
    v_subrev_u32 v228, 131072, v228
    v_subrev_u32 v229, 131072, v229
    v_subrev_u32 v230, 131072, v230
    v_subrev_u32 v231, 131072, v231
    s_mov_b32 s58, 4294180864
L_nowrap:
    s_add_u32 m0, s40, 32768
    s_add_u32 s41, s58, 786432
    s_nop 0
    buffer_load_dwordx4 v224, s[20:23], s41 offen offset:0 lds
    buffer_load_dwordx4 v225, s[20:23], s41 offen offset:1024 lds
    buffer_load_dwordx4 v226, s[20:23], s41 offen offset:2048 lds
    buffer_load_dwordx4 v227, s[20:23], s41 offen offset:3072 lds
    s_add_u32 m0, s40, 36864
    s_nop 0
    buffer_load_dwordx4 v228, s[20:23], s41 offen offset:0 lds
    buffer_load_dwordx4 v229, s[20:23], s41 offen offset:1024 lds
    buffer_load_dwordx4 v230, s[20:23], s41 offen offset:2048 lds
    buffer_load_dwordx4 v231, s[20:23], s41 offen offset:3072 lds
    s_mul_i32 s34, s57, 28672
    s_mul_i32 s33, s57, 917504
    s_add_u32 s33, s33, 1048576
    s_cmp_eq_u32 s57, 3
    s_cselect_b32 s33, 131072, s33
    s_lshl_b32 s7, s57, 2
    s_lshl_b32 s8, 15, s7
    s_add_u32 s47, s7, 4
    s_and_b32 s47, s47, 15
    s_waitcnt vmcnt(17)
L_dec:
    v_cmp_eq_u32 vcc, s36, v238
    s_nop 4
    s_lshr_b32 s7, vcc_lo, 16
    s_and_b32 s46, s7, vcc_lo
    s_andn2_b32 s7, s8, s46
    s_cbranch_scc0 L_hgo
    s_sleep 1
    buffer_load_dword v238, v237, s[28:31], 0 offen sc1
    s_waitcnt vmcnt(0)
    s_sub_u32 s9, s9, 1
    s_cbranch_scc0 L_dec
L_hgo:
    s_mov_b32 s9, 0x40000
    buffer_load_dwordx4 a[0:3], v148, s[24:27], s34 offen offset:0 sc1
    buffer_load_dwordx4 a[4:7], v148, s[24:27], s34 offen offset:256 sc1
    buffer_load_dwordx4 a[8:11], v148, s[24:27], s34 offen offset:2048 sc1
    buffer_load_dwordx4 a[12:15], v148, s[24:27], s34 offen offset:2304 sc1
    s_add_u32 s34, s34, 4096
    s_cmp_eq_u32 s34, 114688
    s_cselect_b32 s34, 0, s34
    buffer_load_dwordx4 a[16:19], v148, s[24:27], s34 offen offset:0 sc1
    buffer_load_dwordx4 a[20:23], v148, s[24:27], s34 offen offset:256 sc1
    buffer_load_dwordx4 a[24:27], v148, s[24:27], s34 offen offset:2048 sc1
    buffer_load_dwordx4 a[28:31], v148, s[24:27], s34 offen offset:2304 sc1
    s_add_u32 s34, s34, 4096
    s_cmp_eq_u32 s34, 114688
    s_cselect_b32 s34, 0, s34
    buffer_load_dwordx4 a[32:35], v148, s[24:27], s34 offen offset:0 sc1
    buffer_load_dwordx4 a[36:39], v148, s[24:27], s34 offen offset:256 sc1
    buffer_load_dwordx4 a[40:43], v148, s[24:27], s34 offen offset:2048 sc1
    buffer_load_dwordx4 a[44:47], v148, s[24:27], s34 offen offset:2304 sc1
    s_add_u32 s34, s34, 4096
    s_cmp_eq_u32 s34, 114688
    s_cselect_b32 s34, 0, s34
    buffer_load_dwordx4 a[48:51], v148, s[24:27], s34 offen offset:0 sc1
    buffer_load_dwordx4 a[52:55], v148, s[24:27], s34 offen offset:256 sc1
    buffer_load_dwordx4 a[56:59], v148, s[24:27], s34 offen offset:2048 sc1
    buffer_load_dwordx4 a[60:63], v148, s[24:27], s34 offen offset:2304 sc1
    s_add_u32 s34, s34, 4096
    s_cmp_eq_u32 s34, 114688
    s_cselect_b32 s34, 0, s34
    s_waitcnt vmcnt(14) lgkmcnt(14)
    v_mfma_f32_16x16x32_bf16 v[0:3], v[64:67], a[0:3], 0
    ds_read_b64_tr_b16 v[96:97], v140 offset:8192
    buffer_load_dwordx4 a[64:67], v148, s[24:27], s34 offen offset:0 sc1
    v_mfma_f32_16x16x32_bf16 v[4:7], v[64:67], a[4:7], 0
    ds_read_b64_tr_b16 v[98:99], v140 offset:9216
    s_waitcnt lgkmcnt(14)
    buffer_load_dwordx4 a[68:71], v148, s[24:27], s34 offen offset:256 sc1
    v_mfma_f32_16x16x32_bf16 v[8:11], v[68:71], a[0:3], 0
    ds_read_b64_tr_b16 v[100:101], v141 offset:8192
    buffer_load_dwordx4 a[72:75], v148, s[24:27], s34 offen offset:2048 sc1
    v_mfma_f32_16x16x32_bf16 v[12:15], v[68:71], a[4:7], 0
    ds_read_b64_tr_b16 v[102:103], v141 offset:9216
    s_waitcnt lgkmcnt(14)
    buffer_load_dwordx4 a[76:79], v148, s[24:27], s34 offen offset:2304 sc1
    v_mfma_f32_16x16x32_bf16 v[16:19], v[72:75], a[0:3], 0
    ds_read_b64_tr_b16 v[104:105], v142 offset:8192
    v_mfma_f32_16x16x32_bf16 v[20:23], v[72:75], a[4:7], 0
    ds_read_b64_tr_b16 v[106:107], v142 offset:9216
    s_waitcnt lgkmcnt(14)
    v_mfma_f32_16x16x32_bf16 v[24:27], v[76:79], a[0:3], 0
    ds_read_b64_tr_b16 v[108:109], v143 offset:8192
    v_mfma_f32_16x16x32_bf16 v[28:31], v[76:79], a[4:7], 0
    ds_read_b64_tr_b16 v[110:111], v143 offset:9216
    s_waitcnt lgkmcnt(14)
    v_mfma_f32_16x16x32_bf16 v[32:35], v[80:83], a[0:3], 0
    ds_read_b64_tr_b16 v[112:113], v144 offset:8192
    v_mfma_f32_16x16x32_bf16 v[36:39], v[80:83], a[4:7], 0
    ds_read_b64_tr_b16 v[114:115], v144 offset:9216
    s_waitcnt lgkmcnt(14)
    v_mfma_f32_16x16x32_bf16 v[40:43], v[84:87], a[0:3], 0
    ds_read_b64_tr_b16 v[116:117], v145 offset:8192
    v_mfma_f32_16x16x32_bf16 v[44:47], v[84:87], a[4:7], 0
    ds_read_b64_tr_b16 v[118:119], v145 offset:9216
    s_waitcnt lgkmcnt(14)
    v_mfma_f32_16x16x32_bf16 v[48:51], v[88:91], a[0:3], 0
    ds_read_b64_tr_b16 v[120:121], v146 offset:8192
    v_mfma_f32_16x16x32_bf16 v[52:55], v[88:91], a[4:7], 0
    ds_read_b64_tr_b16 v[122:123], v146 offset:9216
    s_waitcnt lgkmcnt(14)
    v_mfma_f32_16x16x32_bf16 v[56:59], v[92:95], a[0:3], 0
    ds_read_b64_tr_b16 v[124:125], v147 offset:8192
    s_add_u32 s34, s34, 4096
    s_cmp_eq_u32 s34, 114688
    s_cselect_b32 s34, 0, s34
    v_mfma_f32_16x16x32_bf16 v[60:63], v[92:95], a[4:7], 0
    ds_read_b64_tr_b16 v[126:127], v147 offset:9216
    s_waitcnt vmcnt(16)
    s_barrier
    s_waitcnt lgkmcnt(14)
    v_mfma_f32_16x16x32_bf16 v[0:3], v[96:99], a[8:11], v[0:3]
    ds_read_b64_tr_b16 v[64:65], v140 offset:16384
    v_mfma_f32_16x16x32_bf16 v[4:7], v[96:99], a[12:15], v[4:7]
    ds_read_b64_tr_b16 v[66:67], v140 offset:17408
    s_waitcnt lgkmcnt(14)
    v_mfma_f32_16x16x32_bf16 v[8:11], v[100:103], a[8:11], v[8:11]
    ds_read_b64_tr_b16 v[68:69], v141 offset:16384
    v_mfma_f32_16x16x32_bf16 v[12:15], v[100:103], a[12:15], v[12:15]
    ds_read_b64_tr_b16 v[70:71], v141 offset:17408
    s_waitcnt lgkmcnt(14)
    v_mfma_f32_16x16x32_bf16 v[16:19], v[104:107], a[8:11], v[16:19]
    ds_read_b64_tr_b16 v[72:73], v142 offset:16384
    v_mfma_f32_16x16x32_bf16 v[20:23], v[104:107], a[12:15], v[20:23]
    ds_read_b64_tr_b16 v[74:75], v142 offset:17408
    s_waitcnt lgkmcnt(14)
    v_mfma_f32_16x16x32_bf16 v[24:27], v[108:111], a[8:11], v[24:27]
    ds_read_b64_tr_b16 v[76:77], v143 offset:16384
    v_mfma_f32_16x16x32_bf16 v[28:31], v[108:111], a[12:15], v[28:31]
    ds_read_b64_tr_b16 v[78:79], v143 offset:17408
    s_waitcnt lgkmcnt(14)
    v_mfma_f32_16x16x32_bf16 v[32:35], v[112:115], a[8:11], v[32:35]
    ds_read_b64_tr_b16 v[80:81], v144 offset:16384
    v_mfma_f32_16x16x32_bf16 v[36:39], v[112:115], a[12:15], v[36:39]
    ds_read_b64_tr_b16 v[82:83], v144 offset:17408
    s_waitcnt lgkmcnt(14)
    v_mfma_f32_16x16x32_bf16 v[40:43], v[116:119], a[8:11], v[40:43]
    ds_read_b64_tr_b16 v[84:85], v145 offset:16384
    v_mfma_f32_16x16x32_bf16 v[44:47], v[116:119], a[12:15], v[44:47]
    ds_read_b64_tr_b16 v[86:87], v145 offset:17408
    s_waitcnt lgkmcnt(14)
    v_mfma_f32_16x16x32_bf16 v[48:51], v[120:123], a[8:11], v[48:51]
    ds_read_b64_tr_b16 v[88:89], v146 offset:16384
    v_mfma_f32_16x16x32_bf16 v[52:55], v[120:123], a[12:15], v[52:55]
    ds_read_b64_tr_b16 v[90:91], v146 offset:17408
    s_waitcnt lgkmcnt(14)
    v_mfma_f32_16x16x32_bf16 v[56:59], v[124:127], a[8:11], v[56:59]
    ds_read_b64_tr_b16 v[92:93], v147 offset:16384
    v_mfma_f32_16x16x32_bf16 v[60:63], v[124:127], a[12:15], v[60:63]
    ds_read_b64_tr_b16 v[94:95], v147 offset:17408
    s_waitcnt vmcnt(14) lgkmcnt(14)
    v_mfma_f32_16x16x32_bf16 v[0:3], v[64:67], a[16:19], v[0:3]
    ds_read_b64_tr_b16 v[96:97], v140 offset:24576
    v_mfma_f32_16x16x32_bf16 v[4:7], v[64:67], a[20:23], v[4:7]
    ds_read_b64_tr_b16 v[98:99], v140 offset:25600
    s_waitcnt lgkmcnt(14)
    v_mfma_f32_16x16x32_bf16 v[8:11], v[68:71], a[16:19], v[8:11]
    ds_read_b64_tr_b16 v[100:101], v141 offset:24576
    buffer_load_dwordx4 a[80:83], v148, s[24:27], s34 offen offset:0 sc1
    v_mfma_f32_16x16x32_bf16 v[12:15], v[68:71], a[20:23], v[12:15]
    ds_read_b64_tr_b16 v[102:103], v141 offset:25600
    s_waitcnt lgkmcnt(14)
    v_mfma_f32_16x16x32_bf16 v[16:19], v[72:75], a[16:19], v[16:19]
    ds_read_b64_tr_b16 v[104:105], v142 offset:24576
    v_mfma_f32_16x16x32_bf16 v[20:23], v[72:75], a[20:23], v[20:23]
    ds_read_b64_tr_b16 v[106:107], v142 offset:25600
    s_waitcnt lgkmcnt(14)
    v_mfma_f32_16x16x32_bf16 v[24:27], v[76:79], a[16:19], v[24:27]
    ds_read_b64_tr_b16 v[108:109], v143 offset:24576
    buffer_load_dwordx4 a[84:87], v148, s[24:27], s34 offen offset:256 sc1
    v_mfma_f32_16x16x32_bf16 v[28:31], v[76:79], a[20:23], v[28:31]
    ds_read_b64_tr_b16 v[110:111], v143 offset:25600
    s_waitcnt lgkmcnt(14)
    v_mfma_f32_16x16x32_bf16 v[32:35], v[80:83], a[16:19], v[32:35]
    ds_read_b64_tr_b16 v[112:113], v144 offset:24576
    v_mfma_f32_16x16x32_bf16 v[36:39], v[80:83], a[20:23], v[36:39]
    ds_read_b64_tr_b16 v[114:115], v144 offset:25600
    s_waitcnt lgkmcnt(14)
    v_mfma_f32_16x16x32_bf16 v[40:43], v[84:87], a[16:19], v[40:43]
    ds_read_b64_tr_b16 v[116:117], v145 offset:24576
    buffer_load_dwordx4 a[88:91], v148, s[24:27], s34 offen offset:2048 sc1
    v_mfma_f32_16x16x32_bf16 v[44:47], v[84:87], a[20:23], v[44:47]
    ds_read_b64_tr_b16 v[118:119], v145 offset:25600
    s_waitcnt lgkmcnt(14)
    v_mfma_f32_16x16x32_bf16 v[48:51], v[88:91], a[16:19], v[48:51]
    ds_read_b64_tr_b16 v[120:121], v146 offset:24576
    v_mfma_f32_16x16x32_bf16 v[52:55], v[88:91], a[20:23], v[52:55]
    ds_read_b64_tr_b16 v[122:123], v146 offset:25600
    s_waitcnt lgkmcnt(14)
    v_mfma_f32_16x16x32_bf16 v[56:59], v[92:95], a[16:19], v[56:59]
    ds_read_b64_tr_b16 v[124:125], v147 offset:24576
    buffer_load_dwordx4 a[92:95], v148, s[24:27], s34 offen offset:2304 sc1
    s_add_u32 s34, s34, 4096
    s_cmp_eq_u32 s34, 114688
    s_cselect_b32 s34, 0, s34
    v_mfma_f32_16x16x32_bf16 v[60:63], v[92:95], a[20:23], v[60:63]
    ds_read_b64_tr_b16 v[126:127], v147 offset:25600
    s_waitcnt vmcnt(16)
    s_barrier
    s_waitcnt lgkmcnt(14)
    v_mfma_f32_16x16x32_bf16 v[0:3], v[96:99], a[24:27], v[0:3]
    ds_read_b64_tr_b16 v[64:65], v140 offset:32768
    v_mfma_f32_16x16x32_bf16 v[4:7], v[96:99], a[28:31], v[4:7]
    ds_read_b64_tr_b16 v[66:67], v140 offset:33792
    s_waitcnt lgkmcnt(14)
    s_add_u32 m0, s35, 98304
    v_mfma_f32_16x16x32_bf16 v[8:11], v[100:103], a[24:27], v[8:11]
    ds_read_b64_tr_b16 v[68:69], v141 offset:32768
    buffer_load_dwordx4 v128, s[20:23], s33 offen offset:0 lds
    v_mfma_f32_16x16x32_bf16 v[12:15], v[100:103], a[28:31], v[12:15]
    ds_read_b64_tr_b16 v[70:71], v141 offset:33792
    s_waitcnt lgkmcnt(14)
    v_mfma_f32_16x16x32_bf16 v[16:19], v[104:107], a[24:27], v[16:19]
    ds_read_b64_tr_b16 v[72:73], v142 offset:32768
    v_mfma_f32_16x16x32_bf16 v[20:23], v[104:107], a[28:31], v[20:23]
    ds_read_b64_tr_b16 v[74:75], v142 offset:33792
    s_waitcnt lgkmcnt(14)
    v_mfma_f32_16x16x32_bf16 v[24:27], v[108:111], a[24:27], v[24:27]
    ds_read_b64_tr_b16 v[76:77], v143 offset:32768
    buffer_load_dwordx4 v129, s[20:23], s33 offen offset:1024 lds
    v_mfma_f32_16x16x32_bf16 v[28:31], v[108:111], a[28:31], v[28:31]
    ds_read_b64_tr_b16 v[78:79], v143 offset:33792
    s_waitcnt lgkmcnt(14)
    v_mfma_f32_16x16x32_bf16 v[32:35], v[112:115], a[24:27], v[32:35]
    ds_read_b64_tr_b16 v[80:81], v144 offset:32768
    v_mfma_f32_16x16x32_bf16 v[36:39], v[112:115], a[28:31], v[36:39]
    ds_read_b64_tr_b16 v[82:83], v144 offset:33792
    s_waitcnt lgkmcnt(14)
    v_mfma_f32_16x16x32_bf16 v[40:43], v[116:119], a[24:27], v[40:43]
    ds_read_b64_tr_b16 v[84:85], v145 offset:32768
    buffer_load_dwordx4 v130, s[20:23], s33 offen offset:2048 lds
    v_mfma_f32_16x16x32_bf16 v[44:47], v[116:119], a[28:31], v[44:47]
    ds_read_b64_tr_b16 v[86:87], v145 offset:33792
    s_waitcnt lgkmcnt(14)
    v_mfma_f32_16x16x32_bf16 v[48:51], v[120:123], a[24:27], v[48:51]
    ds_read_b64_tr_b16 v[88:89], v146 offset:32768
    v_mfma_f32_16x16x32_bf16 v[52:55], v[120:123], a[28:31], v[52:55]
    ds_read_b64_tr_b16 v[90:91], v146 offset:33792
    s_waitcnt lgkmcnt(14)
    v_mfma_f32_16x16x32_bf16 v[56:59], v[124:127], a[24:27], v[56:59]
    ds_read_b64_tr_b16 v[92:93], v147 offset:32768
    buffer_load_dwordx4 v131, s[20:23], s33 offen offset:3072 lds
    s_add_u32 s33, s33, 131072
    s_cmp_eq_u32 s33, 3670016
    s_cselect_b32 s33, 0, s33
    v_mfma_f32_16x16x32_bf16 v[60:63], v[124:127], a[28:31], v[60:63]
    ds_read_b64_tr_b16 v[94:95], v147 offset:33792
    s_waitcnt vmcnt(18) lgkmcnt(14)
    v_mfma_f32_16x16x32_bf16 v[0:3], v[64:67], a[32:35], v[0:3]
    ds_read_b64_tr_b16 v[96:97], v140 offset:40960
    v_mfma_f32_16x16x32_bf16 v[4:7], v[64:67], a[36:39], v[4:7]
    ds_read_b64_tr_b16 v[98:99], v140 offset:41984
    s_waitcnt lgkmcnt(14)
    v_mfma_f32_16x16x32_bf16 v[8:11], v[68:71], a[32:35], v[8:11]
    ds_read_b64_tr_b16 v[100:101], v141 offset:40960
    buffer_load_dwordx4 a[96:99], v148, s[24:27], s34 offen offset:0 sc1
    v_mfma_f32_16x16x32_bf16 v[12:15], v[68:71], a[36:39], v[12:15]
    ds_read_b64_tr_b16 v[102:103], v141 offset:41984
    s_waitcnt lgkmcnt(14)
    v_mfma_f32_16x16x32_bf16 v[16:19], v[72:75], a[32:35], v[16:19]
    ds_read_b64_tr_b16 v[104:105], v142 offset:40960
    v_mfma_f32_16x16x32_bf16 v[20:23], v[72:75], a[36:39], v[20:23]
    ds_read_b64_tr_b16 v[106:107], v142 offset:41984
    s_waitcnt lgkmcnt(14)
    v_mfma_f32_16x16x32_bf16 v[24:27], v[76:79], a[32:35], v[24:27]
    ds_read_b64_tr_b16 v[108:109], v143 offset:40960
    buffer_load_dwordx4 a[100:103], v148, s[24:27], s34 offen offset:256 sc1
    v_mfma_f32_16x16x32_bf16 v[28:31], v[76:79], a[36:39], v[28:31]
    ds_read_b64_tr_b16 v[110:111], v143 offset:41984
    s_waitcnt lgkmcnt(14)
    v_mfma_f32_16x16x32_bf16 v[32:35], v[80:83], a[32:35], v[32:35]
    ds_read_b64_tr_b16 v[112:113], v144 offset:40960
    v_mfma_f32_16x16x32_bf16 v[36:39], v[80:83], a[36:39], v[36:39]
    ds_read_b64_tr_b16 v[114:115], v144 offset:41984
    s_waitcnt lgkmcnt(14)
    v_mfma_f32_16x16x32_bf16 v[40:43], v[84:87], a[32:35], v[40:43]
    ds_read_b64_tr_b16 v[116:117], v145 offset:40960
    buffer_load_dwordx4 a[104:107], v148, s[24:27], s34 offen offset:2048 sc1
    v_mfma_f32_16x16x32_bf16 v[44:47], v[84:87], a[36:39], v[44:47]
    ds_read_b64_tr_b16 v[118:119], v145 offset:41984
    s_waitcnt lgkmcnt(14)
    v_mfma_f32_16x16x32_bf16 v[48:51], v[88:91], a[32:35], v[48:51]
    ds_read_b64_tr_b16 v[120:121], v146 offset:40960
    v_mfma_f32_16x16x32_bf16 v[52:55], v[88:91], a[36:39], v[52:55]
    ds_read_b64_tr_b16 v[122:123], v146 offset:41984
    s_waitcnt lgkmcnt(14)
    v_mfma_f32_16x16x32_bf16 v[56:59], v[92:95], a[32:35], v[56:59]
    ds_read_b64_tr_b16 v[124:125], v147 offset:40960
    buffer_load_dwordx4 a[108:111], v148, s[24:27], s34 offen offset:2304 sc1
    s_add_u32 s34, s34, 4096
    s_cmp_eq_u32 s34, 114688
    s_cselect_b32 s34, 0, s34
    v_mfma_f32_16x16x32_bf16 v[60:63], v[92:95], a[36:39], v[60:63]
    ds_read_b64_tr_b16 v[126:127], v147 offset:41984
    s_waitcnt vmcnt(20)
    s_barrier
    s_waitcnt lgkmcnt(14)
    v_mfma_f32_16x16x32_bf16 v[0:3], v[96:99], a[40:43], v[0:3]
    ds_read_b64_tr_b16 v[64:65], v140 offset:49152
    v_mfma_f32_16x16x32_bf16 v[4:7], v[96:99], a[44:47], v[4:7]
    ds_read_b64_tr_b16 v[66:67], v140 offset:50176
    s_waitcnt lgkmcnt(14)
    s_add_u32 m0, s35, 114688
    v_mfma_f32_16x16x32_bf16 v[8:11], v[100:103], a[40:43], v[8:11]
    ds_read_b64_tr_b16 v[68:69], v141 offset:49152
    buffer_load_dwordx4 v128, s[20:23], s33 offen offset:0 lds
    v_mfma_f32_16x16x32_bf16 v[12:15], v[100:103], a[44:47], v[12:15]
    ds_read_b64_tr_b16 v[70:71], v141 offset:50176
    s_waitcnt lgkmcnt(14)
    v_mfma_f32_16x16x32_bf16 v[16:19], v[104:107], a[40:43], v[16:19]
    ds_read_b64_tr_b16 v[72:73], v142 offset:49152
    v_mfma_f32_16x16x32_bf16 v[20:23], v[104:107], a[44:47], v[20:23]
    ds_read_b64_tr_b16 v[74:75], v142 offset:50176
    s_waitcnt lgkmcnt(14)
    v_mfma_f32_16x16x32_bf16 v[24:27], v[108:111], a[40:43], v[24:27]
    ds_read_b64_tr_b16 v[76:77], v143 offset:49152
    buffer_load_dwordx4 v129, s[20:23], s33 offen offset:1024 lds
    v_mfma_f32_16x16x32_bf16 v[28:31], v[108:111], a[44:47], v[28:31]
    ds_read_b64_tr_b16 v[78:79], v143 offset:50176
    s_waitcnt lgkmcnt(14)
    v_mfma_f32_16x16x32_bf16 v[32:35], v[112:115], a[40:43], v[32:35]
    ds_read_b64_tr_b16 v[80:81], v144 offset:49152
    v_mfma_f32_16x16x32_bf16 v[36:39], v[112:115], a[44:47], v[36:39]
    ds_read_b64_tr_b16 v[82:83], v144 offset:50176
    s_waitcnt lgkmcnt(14)
    v_mfma_f32_16x16x32_bf16 v[40:43], v[116:119], a[40:43], v[40:43]
    ds_read_b64_tr_b16 v[84:85], v145 offset:49152
    buffer_load_dwordx4 v130, s[20:23], s33 offen offset:2048 lds
    v_mfma_f32_16x16x32_bf16 v[44:47], v[116:119], a[44:47], v[44:47]
    ds_read_b64_tr_b16 v[86:87], v145 offset:50176
    s_waitcnt lgkmcnt(14)
    v_mfma_f32_16x16x32_bf16 v[48:51], v[120:123], a[40:43], v[48:51]
    ds_read_b64_tr_b16 v[88:89], v146 offset:49152
    s_lshl_b32 s8, 15, s47
    s_andn2_b32 s7, s8, s46
    s_cbranch_scc1 L2_w3
    L2_b3:
    v_mfma_f32_16x16x32_bf16 v[52:55], v[120:123], a[44:47], v[52:55]
    ds_read_b64_tr_b16 v[90:91], v146 offset:50176
    s_waitcnt lgkmcnt(14)
    s_add_u32 s47, s47, 4
    s_and_b32 s47, s47, 15
    v_mfma_f32_16x16x32_bf16 v[56:59], v[124:127], a[40:43], v[56:59]
    ds_read_b64_tr_b16 v[92:93], v147 offset:49152
    buffer_load_dwordx4 v131, s[20:23], s33 offen offset:3072 lds
    s_add_u32 s33, s33, 131072
    s_cmp_eq_u32 s33, 3670016
    s_cselect_b32 s33, 0, s33
    v_mfma_f32_16x16x32_bf16 v[60:63], v[124:127], a[44:47], v[60:63]
    ds_read_b64_tr_b16 v[94:95], v147 offset:50176
    s_waitcnt vmcnt(22) lgkmcnt(14)
    v_mfma_f32_16x16x32_bf16 v[0:3], v[64:67], a[48:51], v[0:3]
    ds_read_b64_tr_b16 v[96:97], v140 offset:57344
    v_mfma_f32_16x16x32_bf16 v[4:7], v[64:67], a[52:55], v[4:7]
    ds_read_b64_tr_b16 v[98:99], v140 offset:58368
    s_waitcnt lgkmcnt(14)
    v_mfma_f32_16x16x32_bf16 v[8:11], v[68:71], a[48:51], v[8:11]
    ds_read_b64_tr_b16 v[100:101], v141 offset:57344
    buffer_load_dwordx4 a[112:115], v148, s[24:27], s34 offen offset:0 sc1
    v_mfma_f32_16x16x32_bf16 v[12:15], v[68:71], a[52:55], v[12:15]
    ds_read_b64_tr_b16 v[102:103], v141 offset:58368
    s_waitcnt lgkmcnt(14)
    v_mfma_f32_16x16x32_bf16 v[16:19], v[72:75], a[48:51], v[16:19]
    ds_read_b64_tr_b16 v[104:105], v142 offset:57344
    v_mfma_f32_16x16x32_bf16 v[20:23], v[72:75], a[52:55], v[20:23]
    ds_read_b64_tr_b16 v[106:107], v142 offset:58368
    s_waitcnt lgkmcnt(14)
    v_mfma_f32_16x16x32_bf16 v[24:27], v[76:79], a[48:51], v[24:27]
    ds_read_b64_tr_b16 v[108:109], v143 offset:57344
    buffer_load_dwordx4 a[116:119], v148, s[24:27], s34 offen offset:256 sc1
    v_mfma_f32_16x16x32_bf16 v[28:31], v[76:79], a[52:55], v[28:31]
    ds_read_b64_tr_b16 v[110:111], v143 offset:58368
    s_waitcnt lgkmcnt(14)
    v_mfma_f32_16x16x32_bf16 v[32:35], v[80:83], a[48:51], v[32:35]
    ds_read_b64_tr_b16 v[112:113], v144 offset:57344
    v_mfma_f32_16x16x32_bf16 v[36:39], v[80:83], a[52:55], v[36:39]
    ds_read_b64_tr_b16 v[114:115], v144 offset:58368
    s_waitcnt lgkmcnt(14)
    v_mfma_f32_16x16x32_bf16 v[40:43], v[84:87], a[48:51], v[40:43]
    ds_read_b64_tr_b16 v[116:117], v145 offset:57344
    buffer_load_dwordx4 a[120:123], v148, s[24:27], s34 offen offset:2048 sc1
    v_mfma_f32_16x16x32_bf16 v[44:47], v[84:87], a[52:55], v[44:47]
    ds_read_b64_tr_b16 v[118:119], v145 offset:58368
    s_waitcnt lgkmcnt(14)
    v_mfma_f32_16x16x32_bf16 v[48:51], v[88:91], a[48:51], v[48:51]
    ds_read_b64_tr_b16 v[120:121], v146 offset:57344
    v_mfma_f32_16x16x32_bf16 v[52:55], v[88:91], a[52:55], v[52:55]
    ds_read_b64_tr_b16 v[122:123], v146 offset:58368
    s_waitcnt lgkmcnt(14)
    v_mfma_f32_16x16x32_bf16 v[56:59], v[92:95], a[48:51], v[56:59]
    ds_read_b64_tr_b16 v[124:125], v147 offset:57344
    buffer_load_dwordx4 a[124:127], v148, s[24:27], s34 offen offset:2304 sc1
    s_add_u32 s34, s34, 4096
    s_cmp_eq_u32 s34, 114688
    s_cselect_b32 s34, 0, s34
    v_mfma_f32_16x16x32_bf16 v[60:63], v[92:95], a[52:55], v[60:63]
    ds_read_b64_tr_b16 v[126:127], v147 offset:58368
.p2align 6
L2_loop:
    s_waitcnt vmcnt(24)
    s_barrier
    s_waitcnt lgkmcnt(14)
    v_mfma_f32_16x16x32_bf16 v[0:3], v[96:99], a[56:59], v[0:3]
    ds_read_b64_tr_b16 v[64:65], v132 offset:0
    v_mfma_f32_16x16x32_bf16 v[4:7], v[96:99], a[60:63], v[4:7]
    ds_read_b64_tr_b16 v[66:67], v132 offset:1024
    s_waitcnt lgkmcnt(14)
    s_add_u32 m0, s35, 131072
    v_mfma_f32_16x16x32_bf16 v[8:11], v[100:103], a[56:59], v[8:11]
    ds_read_b64_tr_b16 v[68:69], v133 offset:0
    buffer_load_dwordx4 v128, s[20:23], s33 offen offset:0 lds
    v_mfma_f32_16x16x32_bf16 v[12:15], v[100:103], a[60:63], v[12:15]
    ds_read_b64_tr_b16 v[70:71], v133 offset:1024
    s_waitcnt lgkmcnt(14)
    v_mfma_f32_16x16x32_bf16 v[16:19], v[104:107], a[56:59], v[16:19]
    ds_read_b64_tr_b16 v[72:73], v134 offset:0
    v_mfma_f32_16x16x32_bf16 v[20:23], v[104:107], a[60:63], v[20:23]
    ds_read_b64_tr_b16 v[74:75], v134 offset:1024
    s_waitcnt lgkmcnt(14)
    v_mfma_f32_16x16x32_bf16 v[24:27], v[108:111], a[56:59], v[24:27]
    ds_read_b64_tr_b16 v[76:77], v135 offset:0
    buffer_load_dwordx4 v129, s[20:23], s33 offen offset:1024 lds
    v_mfma_f32_16x16x32_bf16 v[28:31], v[108:111], a[60:63], v[28:31]
    ds_read_b64_tr_b16 v[78:79], v135 offset:1024
    s_waitcnt lgkmcnt(14)
    v_mfma_f32_16x16x32_bf16 v[32:35], v[112:115], a[56:59], v[32:35]
    ds_read_b64_tr_b16 v[80:81], v136 offset:0
    v_mfma_f32_16x16x32_bf16 v[36:39], v[112:115], a[60:63], v[36:39]
    ds_read_b64_tr_b16 v[82:83], v136 offset:1024
    s_waitcnt lgkmcnt(14)
    v_mfma_f32_16x16x32_bf16 v[40:43], v[116:119], a[56:59], v[40:43]
    ds_read_b64_tr_b16 v[84:85], v137 offset:0
    buffer_load_dwordx4 v130, s[20:23], s33 offen offset:2048 lds
    v_mfma_f32_16x16x32_bf16 v[44:47], v[116:119], a[60:63], v[44:47]
    ds_read_b64_tr_b16 v[86:87], v137 offset:1024
    s_waitcnt lgkmcnt(14)
    v_mfma_f32_16x16x32_bf16 v[48:51], v[120:123], a[56:59], v[48:51]
    ds_read_b64_tr_b16 v[88:89], v138 offset:0
    v_mfma_f32_16x16x32_bf16 v[52:55], v[120:123], a[60:63], v[52:55]
    ds_read_b64_tr_b16 v[90:91], v138 offset:1024
    s_waitcnt lgkmcnt(14)
    v_mfma_f32_16x16x32_bf16 v[56:59], v[124:127], a[56:59], v[56:59]
    ds_read_b64_tr_b16 v[92:93], v139 offset:0
    buffer_load_dwordx4 v131, s[20:23], s33 offen offset:3072 lds
    s_add_u32 s33, s33, 131072
    s_cmp_eq_u32 s33, 3670016
    s_cselect_b32 s33, 0, s33
    v_mfma_f32_16x16x32_bf16 v[60:63], v[124:127], a[60:63], v[60:63]
    ds_read_b64_tr_b16 v[94:95], v139 offset:1024
    s_waitcnt vmcnt(26) lgkmcnt(14)
    v_mfma_f32_16x16x32_bf16 v[0:3], v[64:67], a[64:67], v[0:3]
    ds_read_b64_tr_b16 v[96:97], v132 offset:8192
    v_mfma_f32_16x16x32_bf16 v[4:7], v[64:67], a[68:71], v[4:7]
    ds_read_b64_tr_b16 v[98:99], v132 offset:9216
    s_waitcnt lgkmcnt(14)
    v_mfma_f32_16x16x32_bf16 v[8:11], v[68:71], a[64:67], v[8:11]
    ds_read_b64_tr_b16 v[100:101], v133 offset:8192
    buffer_load_dwordx4 a[0:3], v148, s[24:27], s34 offen offset:0 sc1
    v_mfma_f32_16x16x32_bf16 v[12:15], v[68:71], a[68:71], v[12:15]
    ds_read_b64_tr_b16 v[102:103], v133 offset:9216
    s_waitcnt lgkmcnt(14)
    v_mfma_f32_16x16x32_bf16 v[16:19], v[72:75], a[64:67], v[16:19]
    ds_read_b64_tr_b16 v[104:105], v134 offset:8192
    v_mfma_f32_16x16x32_bf16 v[20:23], v[72:75], a[68:71], v[20:23]
    ds_read_b64_tr_b16 v[106:107], v134 offset:9216
    s_waitcnt lgkmcnt(14)
    v_mfma_f32_16x16x32_bf16 v[24:27], v[76:79], a[64:67], v[24:27]
    ds_read_b64_tr_b16 v[108:109], v135 offset:8192
    buffer_load_dwordx4 a[4:7], v148, s[24:27], s34 offen offset:256 sc1
    v_mfma_f32_16x16x32_bf16 v[28:31], v[76:79], a[68:71], v[28:31]
    ds_read_b64_tr_b16 v[110:111], v135 offset:9216
    s_waitcnt lgkmcnt(14)
    v_mfma_f32_16x16x32_bf16 v[32:35], v[80:83], a[64:67], v[32:35]
    ds_read_b64_tr_b16 v[112:113], v136 offset:8192
    v_mfma_f32_16x16x32_bf16 v[36:39], v[80:83], a[68:71], v[36:39]
    ds_read_b64_tr_b16 v[114:115], v136 offset:9216
    s_waitcnt lgkmcnt(14)
    v_mfma_f32_16x16x32_bf16 v[40:43], v[84:87], a[64:67], v[40:43]
    ds_read_b64_tr_b16 v[116:117], v137 offset:8192
    buffer_load_dwordx4 a[8:11], v148, s[24:27], s34 offen offset:2048 sc1
    v_mfma_f32_16x16x32_bf16 v[44:47], v[84:87], a[68:71], v[44:47]
    ds_read_b64_tr_b16 v[118:119], v137 offset:9216
    s_waitcnt lgkmcnt(14)
    v_mfma_f32_16x16x32_bf16 v[48:51], v[88:91], a[64:67], v[48:51]
    ds_read_b64_tr_b16 v[120:121], v138 offset:8192
    v_mfma_f32_16x16x32_bf16 v[52:55], v[88:91], a[68:71], v[52:55]
    ds_read_b64_tr_b16 v[122:123], v138 offset:9216
    s_waitcnt lgkmcnt(14)
    v_mfma_f32_16x16x32_bf16 v[56:59], v[92:95], a[64:67], v[56:59]
    ds_read_b64_tr_b16 v[124:125], v139 offset:8192
    buffer_load_dwordx4 a[12:15], v148, s[24:27], s34 offen offset:2304 sc1
    s_add_u32 s34, s34, 4096
    s_cmp_eq_u32 s34, 114688
    s_cselect_b32 s34, 0, s34
    v_mfma_f32_16x16x32_bf16 v[60:63], v[92:95], a[68:71], v[60:63]
    ds_read_b64_tr_b16 v[126:127], v139 offset:9216
    s_waitcnt vmcnt(28)
    s_barrier
    s_waitcnt lgkmcnt(14)
    v_mfma_f32_16x16x32_bf16 v[0:3], v[96:99], a[72:75], v[0:3]
    ds_read_b64_tr_b16 v[64:65], v132 offset:16384
    v_mfma_f32_16x16x32_bf16 v[4:7], v[96:99], a[76:79], v[4:7]
    ds_read_b64_tr_b16 v[66:67], v132 offset:17408
    s_waitcnt lgkmcnt(14)
    s_add_u32 m0, s35, 147456
    v_mfma_f32_16x16x32_bf16 v[8:11], v[100:103], a[72:75], v[8:11]
    ds_read_b64_tr_b16 v[68:69], v133 offset:16384
    buffer_load_dwordx4 v128, s[20:23], s33 offen offset:0 lds
    v_mfma_f32_16x16x32_bf16 v[12:15], v[100:103], a[76:79], v[12:15]
    ds_read_b64_tr_b16 v[70:71], v133 offset:17408
    s_waitcnt lgkmcnt(14)
    v_mfma_f32_16x16x32_bf16 v[16:19], v[104:107], a[72:75], v[16:19]
    ds_read_b64_tr_b16 v[72:73], v134 offset:16384
    v_mfma_f32_16x16x32_bf16 v[20:23], v[104:107], a[76:79], v[20:23]
    ds_read_b64_tr_b16 v[74:75], v134 offset:17408
    s_waitcnt lgkmcnt(14)
    v_mfma_f32_16x16x32_bf16 v[24:27], v[108:111], a[72:75], v[24:27]
    ds_read_b64_tr_b16 v[76:77], v135 offset:16384
    buffer_load_dwordx4 v129, s[20:23], s33 offen offset:1024 lds
    v_mfma_f32_16x16x32_bf16 v[28:31], v[108:111], a[76:79], v[28:31]
    ds_read_b64_tr_b16 v[78:79], v135 offset:17408
    s_waitcnt lgkmcnt(14)
    v_mfma_f32_16x16x32_bf16 v[32:35], v[112:115], a[72:75], v[32:35]
    ds_read_b64_tr_b16 v[80:81], v136 offset:16384
    v_mfma_f32_16x16x32_bf16 v[36:39], v[112:115], a[76:79], v[36:39]
    ds_read_b64_tr_b16 v[82:83], v136 offset:17408
    s_waitcnt lgkmcnt(14)
    v_mfma_f32_16x16x32_bf16 v[40:43], v[116:119], a[72:75], v[40:43]
    ds_read_b64_tr_b16 v[84:85], v137 offset:16384
    buffer_load_dwordx4 v130, s[20:23], s33 offen offset:2048 lds
    v_mfma_f32_16x16x32_bf16 v[44:47], v[116:119], a[76:79], v[44:47]
    ds_read_b64_tr_b16 v[86:87], v137 offset:17408
    s_waitcnt lgkmcnt(14)
    v_mfma_f32_16x16x32_bf16 v[48:51], v[120:123], a[72:75], v[48:51]
    ds_read_b64_tr_b16 v[88:89], v138 offset:16384
    v_mfma_f32_16x16x32_bf16 v[52:55], v[120:123], a[76:79], v[52:55]
    ds_read_b64_tr_b16 v[90:91], v138 offset:17408
    s_waitcnt lgkmcnt(14)
    v_mfma_f32_16x16x32_bf16 v[56:59], v[124:127], a[72:75], v[56:59]
    ds_read_b64_tr_b16 v[92:93], v139 offset:16384
    buffer_load_dwordx4 v131, s[20:23], s33 offen offset:3072 lds
    s_add_u32 s33, s33, 131072
    s_cmp_eq_u32 s33, 3670016
    s_cselect_b32 s33, 0, s33
    v_mfma_f32_16x16x32_bf16 v[60:63], v[124:127], a[76:79], v[60:63]
    ds_read_b64_tr_b16 v[94:95], v139 offset:17408
    s_waitcnt vmcnt(30) lgkmcnt(14)
    v_mfma_f32_16x16x32_bf16 v[0:3], v[64:67], a[80:83], v[0:3]
    ds_read_b64_tr_b16 v[96:97], v132 offset:24576
    v_mfma_f32_16x16x32_bf16 v[4:7], v[64:67], a[84:87], v[4:7]
    ds_read_b64_tr_b16 v[98:99], v132 offset:25600
    s_waitcnt lgkmcnt(14)
    v_mfma_f32_16x16x32_bf16 v[8:11], v[68:71], a[80:83], v[8:11]
    ds_read_b64_tr_b16 v[100:101], v133 offset:24576
    buffer_load_dwordx4 a[16:19], v148, s[24:27], s34 offen offset:0 sc1
    v_mfma_f32_16x16x32_bf16 v[12:15], v[68:71], a[84:87], v[12:15]
    ds_read_b64_tr_b16 v[102:103], v133 offset:25600
    s_waitcnt lgkmcnt(14)
    v_mfma_f32_16x16x32_bf16 v[16:19], v[72:75], a[80:83], v[16:19]
    ds_read_b64_tr_b16 v[104:105], v134 offset:24576
    v_mfma_f32_16x16x32_bf16 v[20:23], v[72:75], a[84:87], v[20:23]
    ds_read_b64_tr_b16 v[106:107], v134 offset:25600
    s_waitcnt lgkmcnt(14)
    v_mfma_f32_16x16x32_bf16 v[24:27], v[76:79], a[80:83], v[24:27]
    ds_read_b64_tr_b16 v[108:109], v135 offset:24576
    buffer_load_dwordx4 a[20:23], v148, s[24:27], s34 offen offset:256 sc1
    v_mfma_f32_16x16x32_bf16 v[28:31], v[76:79], a[84:87], v[28:31]
    ds_read_b64_tr_b16 v[110:111], v135 offset:25600
    s_waitcnt lgkmcnt(14)
    v_mfma_f32_16x16x32_bf16 v[32:35], v[80:83], a[80:83], v[32:35]
    ds_read_b64_tr_b16 v[112:113], v136 offset:24576
    v_mfma_f32_16x16x32_bf16 v[36:39], v[80:83], a[84:87], v[36:39]
    ds_read_b64_tr_b16 v[114:115], v136 offset:25600
    s_waitcnt lgkmcnt(14)
    v_mfma_f32_16x16x32_bf16 v[40:43], v[84:87], a[80:83], v[40:43]
    ds_read_b64_tr_b16 v[116:117], v137 offset:24576
    buffer_load_dwordx4 a[24:27], v148, s[24:27], s34 offen offset:2048 sc1
    v_mfma_f32_16x16x32_bf16 v[44:47], v[84:87], a[84:87], v[44:47]
    ds_read_b64_tr_b16 v[118:119], v137 offset:25600
    s_waitcnt lgkmcnt(14)
    v_mfma_f32_16x16x32_bf16 v[48:51], v[88:91], a[80:83], v[48:51]
    ds_read_b64_tr_b16 v[120:121], v138 offset:24576
    v_mfma_f32_16x16x32_bf16 v[52:55], v[88:91], a[84:87], v[52:55]
    ds_read_b64_tr_b16 v[122:123], v138 offset:25600
    s_waitcnt lgkmcnt(14)
    v_mfma_f32_16x16x32_bf16 v[56:59], v[92:95], a[80:83], v[56:59]
    ds_read_b64_tr_b16 v[124:125], v139 offset:24576
    buffer_load_dwordx4 a[28:31], v148, s[24:27], s34 offen offset:2304 sc1
    s_add_u32 s34, s34, 4096
    s_cmp_eq_u32 s34, 114688
    s_cselect_b32 s34, 0, s34
    v_mfma_f32_16x16x32_bf16 v[60:63], v[92:95], a[84:87], v[60:63]
    ds_read_b64_tr_b16 v[126:127], v139 offset:25600
    s_waitcnt vmcnt(32)
    s_barrier
    s_waitcnt lgkmcnt(14)
    v_mfma_f32_16x16x32_bf16 v[0:3], v[96:99], a[88:91], v[0:3]
    ds_read_b64_tr_b16 v[64:65], v132 offset:32768
    v_mfma_f32_16x16x32_bf16 v[4:7], v[96:99], a[92:95], v[4:7]
    ds_read_b64_tr_b16 v[66:67], v132 offset:33792
    s_waitcnt lgkmcnt(14)
    s_add_u32 m0, s35, 0
    v_mfma_f32_16x16x32_bf16 v[8:11], v[100:103], a[88:91], v[8:11]
    ds_read_b64_tr_b16 v[68:69], v133 offset:32768
    buffer_load_dwordx4 v128, s[20:23], s33 offen offset:0 lds
    v_mfma_f32_16x16x32_bf16 v[12:15], v[100:103], a[92:95], v[12:15]
    ds_read_b64_tr_b16 v[70:71], v133 offset:33792
    s_waitcnt lgkmcnt(14)
    v_mfma_f32_16x16x32_bf16 v[16:19], v[104:107], a[88:91], v[16:19]
    ds_read_b64_tr_b16 v[72:73], v134 offset:32768
    v_mfma_f32_16x16x32_bf16 v[20:23], v[104:107], a[92:95], v[20:23]
    ds_read_b64_tr_b16 v[74:75], v134 offset:33792
    s_waitcnt lgkmcnt(14)
    v_mfma_f32_16x16x32_bf16 v[24:27], v[108:111], a[88:91], v[24:27]
    ds_read_b64_tr_b16 v[76:77], v135 offset:32768
    buffer_load_dwordx4 v129, s[20:23], s33 offen offset:1024 lds
    v_mfma_f32_16x16x32_bf16 v[28:31], v[108:111], a[92:95], v[28:31]
    ds_read_b64_tr_b16 v[78:79], v135 offset:33792
    s_waitcnt lgkmcnt(14)
    v_mfma_f32_16x16x32_bf16 v[32:35], v[112:115], a[88:91], v[32:35]
    ds_read_b64_tr_b16 v[80:81], v136 offset:32768
    v_mfma_f32_16x16x32_bf16 v[36:39], v[112:115], a[92:95], v[36:39]
    ds_read_b64_tr_b16 v[82:83], v136 offset:33792
    s_waitcnt lgkmcnt(14)
    v_mfma_f32_16x16x32_bf16 v[40:43], v[116:119], a[88:91], v[40:43]
    ds_read_b64_tr_b16 v[84:85], v137 offset:32768
    buffer_load_dwordx4 v130, s[20:23], s33 offen offset:2048 lds
    v_mfma_f32_16x16x32_bf16 v[44:47], v[116:119], a[92:95], v[44:47]
    ds_read_b64_tr_b16 v[86:87], v137 offset:33792
    s_waitcnt lgkmcnt(14)
    v_mfma_f32_16x16x32_bf16 v[48:51], v[120:123], a[88:91], v[48:51]
    ds_read_b64_tr_b16 v[88:89], v138 offset:32768
    v_mfma_f32_16x16x32_bf16 v[52:55], v[120:123], a[92:95], v[52:55]
    ds_read_b64_tr_b16 v[90:91], v138 offset:33792
    s_waitcnt lgkmcnt(14)
    v_mfma_f32_16x16x32_bf16 v[56:59], v[124:127], a[88:91], v[56:59]
    ds_read_b64_tr_b16 v[92:93], v139 offset:32768
    buffer_load_dwordx4 v131, s[20:23], s33 offen offset:3072 lds
    s_add_u32 s33, s33, 131072
    s_cmp_eq_u32 s33, 3670016
    s_cselect_b32 s33, 0, s33
    v_mfma_f32_16x16x32_bf16 v[60:63], v[124:127], a[92:95], v[60:63]
    ds_read_b64_tr_b16 v[94:95], v139 offset:33792
    s_waitcnt vmcnt(30) lgkmcnt(14)
    v_mfma_f32_16x16x32_bf16 v[0:3], v[64:67], a[96:99], v[0:3]
    ds_read_b64_tr_b16 v[96:97], v132 offset:40960
    v_mfma_f32_16x16x32_bf16 v[4:7], v[64:67], a[100:103], v[4:7]
    ds_read_b64_tr_b16 v[98:99], v132 offset:41984
    s_waitcnt lgkmcnt(14)
    v_mfma_f32_16x16x32_bf16 v[8:11], v[68:71], a[96:99], v[8:11]
    ds_read_b64_tr_b16 v[100:101], v133 offset:40960
    buffer_load_dwordx4 a[32:35], v148, s[24:27], s34 offen offset:0 sc1
    v_mfma_f32_16x16x32_bf16 v[12:15], v[68:71], a[100:103], v[12:15]
    ds_read_b64_tr_b16 v[102:103], v133 offset:41984
    s_waitcnt lgkmcnt(14)
    v_mfma_f32_16x16x32_bf16 v[16:19], v[72:75], a[96:99], v[16:19]
    ds_read_b64_tr_b16 v[104:105], v134 offset:40960
    v_mfma_f32_16x16x32_bf16 v[20:23], v[72:75], a[100:103], v[20:23]
    ds_read_b64_tr_b16 v[106:107], v134 offset:41984
    s_waitcnt lgkmcnt(14)
    v_mfma_f32_16x16x32_bf16 v[24:27], v[76:79], a[96:99], v[24:27]
    ds_read_b64_tr_b16 v[108:109], v135 offset:40960
    buffer_load_dwordx4 a[36:39], v148, s[24:27], s34 offen offset:256 sc1
    v_mfma_f32_16x16x32_bf16 v[28:31], v[76:79], a[100:103], v[28:31]
    ds_read_b64_tr_b16 v[110:111], v135 offset:41984
    s_waitcnt lgkmcnt(14)
    v_mfma_f32_16x16x32_bf16 v[32:35], v[80:83], a[96:99], v[32:35]
    ds_read_b64_tr_b16 v[112:113], v136 offset:40960
    v_mfma_f32_16x16x32_bf16 v[36:39], v[80:83], a[100:103], v[36:39]
    ds_read_b64_tr_b16 v[114:115], v136 offset:41984
    s_waitcnt lgkmcnt(14)
    v_mfma_f32_16x16x32_bf16 v[40:43], v[84:87], a[96:99], v[40:43]
    ds_read_b64_tr_b16 v[116:117], v137 offset:40960
    buffer_load_dwordx4 a[40:43], v148, s[24:27], s34 offen offset:2048 sc1
    v_mfma_f32_16x16x32_bf16 v[44:47], v[84:87], a[100:103], v[44:47]
    ds_read_b64_tr_b16 v[118:119], v137 offset:41984
    s_waitcnt lgkmcnt(14)
    v_mfma_f32_16x16x32_bf16 v[48:51], v[88:91], a[96:99], v[48:51]
    ds_read_b64_tr_b16 v[120:121], v138 offset:40960
    v_mfma_f32_16x16x32_bf16 v[52:55], v[88:91], a[100:103], v[52:55]
    ds_read_b64_tr_b16 v[122:123], v138 offset:41984
    s_waitcnt lgkmcnt(14)
    v_mfma_f32_16x16x32_bf16 v[56:59], v[92:95], a[96:99], v[56:59]
    ds_read_b64_tr_b16 v[124:125], v139 offset:40960
    buffer_load_dwordx4 a[44:47], v148, s[24:27], s34 offen offset:2304 sc1
    s_add_u32 s34, s34, 4096
    s_cmp_eq_u32 s34, 114688
    s_cselect_b32 s34, 0, s34
    v_mfma_f32_16x16x32_bf16 v[60:63], v[92:95], a[100:103], v[60:63]
    ds_read_b64_tr_b16 v[126:127], v139 offset:41984
    s_waitcnt vmcnt(32)
    s_barrier
    s_waitcnt lgkmcnt(14)
    v_mfma_f32_16x16x32_bf16 v[0:3], v[96:99], a[104:107], v[0:3]
    ds_read_b64_tr_b16 v[64:65], v132 offset:49152
    v_mfma_f32_16x16x32_bf16 v[4:7], v[96:99], a[108:111], v[4:7]
    ds_read_b64_tr_b16 v[66:67], v132 offset:50176
    s_waitcnt lgkmcnt(14)
    s_add_u32 m0, s35, 16384
    v_mfma_f32_16x16x32_bf16 v[8:11], v[100:103], a[104:107], v[8:11]
    ds_read_b64_tr_b16 v[68:69], v133 offset:49152
    buffer_load_dwordx4 v128, s[20:23], s33 offen offset:0 lds
    v_mfma_f32_16x16x32_bf16 v[12:15], v[100:103], a[108:111], v[12:15]
    ds_read_b64_tr_b16 v[70:71], v133 offset:50176
    s_waitcnt lgkmcnt(14)
    v_mfma_f32_16x16x32_bf16 v[16:19], v[104:107], a[104:107], v[16:19]
    ds_read_b64_tr_b16 v[72:73], v134 offset:49152
    v_mfma_f32_16x16x32_bf16 v[20:23], v[104:107], a[108:111], v[20:23]
    ds_read_b64_tr_b16 v[74:75], v134 offset:50176
    s_waitcnt lgkmcnt(14)
    v_mfma_f32_16x16x32_bf16 v[24:27], v[108:111], a[104:107], v[24:27]
    ds_read_b64_tr_b16 v[76:77], v135 offset:49152
    buffer_load_dwordx4 v129, s[20:23], s33 offen offset:1024 lds
    v_mfma_f32_16x16x32_bf16 v[28:31], v[108:111], a[108:111], v[28:31]
    ds_read_b64_tr_b16 v[78:79], v135 offset:50176
    s_waitcnt lgkmcnt(14)
    v_mfma_f32_16x16x32_bf16 v[32:35], v[112:115], a[104:107], v[32:35]
    ds_read_b64_tr_b16 v[80:81], v136 offset:49152
    v_mfma_f32_16x16x32_bf16 v[36:39], v[112:115], a[108:111], v[36:39]
    ds_read_b64_tr_b16 v[82:83], v136 offset:50176
    s_waitcnt lgkmcnt(14)
    v_mfma_f32_16x16x32_bf16 v[40:43], v[116:119], a[104:107], v[40:43]
    ds_read_b64_tr_b16 v[84:85], v137 offset:49152
    buffer_load_dwordx4 v130, s[20:23], s33 offen offset:2048 lds
    v_mfma_f32_16x16x32_bf16 v[44:47], v[116:119], a[108:111], v[44:47]
    ds_read_b64_tr_b16 v[86:87], v137 offset:50176
    s_waitcnt lgkmcnt(14)
    v_mfma_f32_16x16x32_bf16 v[48:51], v[120:123], a[104:107], v[48:51]
    ds_read_b64_tr_b16 v[88:89], v138 offset:49152
    v_mfma_f32_16x16x32_bf16 v[52:55], v[120:123], a[108:111], v[52:55]
    ds_read_b64_tr_b16 v[90:91], v138 offset:50176
    s_waitcnt lgkmcnt(14)
    v_mfma_f32_16x16x32_bf16 v[56:59], v[124:127], a[104:107], v[56:59]
    ds_read_b64_tr_b16 v[92:93], v139 offset:49152
    buffer_load_dwordx4 v131, s[20:23], s33 offen offset:3072 lds
    s_add_u32 s33, s33, 131072
    s_cmp_eq_u32 s33, 3670016
    s_cselect_b32 s33, 0, s33
    v_mfma_f32_16x16x32_bf16 v[60:63], v[124:127], a[108:111], v[60:63]
    ds_read_b64_tr_b16 v[94:95], v139 offset:50176
    s_waitcnt vmcnt(30) lgkmcnt(14)
    v_mfma_f32_16x16x32_bf16 v[0:3], v[64:67], a[112:115], v[0:3]
    ds_read_b64_tr_b16 v[96:97], v132 offset:57344
    v_mfma_f32_16x16x32_bf16 v[4:7], v[64:67], a[116:119], v[4:7]
    ds_read_b64_tr_b16 v[98:99], v132 offset:58368
    s_waitcnt lgkmcnt(14)
    v_mfma_f32_16x16x32_bf16 v[8:11], v[68:71], a[112:115], v[8:11]
    ds_read_b64_tr_b16 v[100:101], v133 offset:57344
    buffer_load_dwordx4 a[48:51], v148, s[24:27], s34 offen offset:0 sc1
    v_mfma_f32_16x16x32_bf16 v[12:15], v[68:71], a[116:119], v[12:15]
    ds_read_b64_tr_b16 v[102:103], v133 offset:58368
    s_waitcnt lgkmcnt(14)
    v_mfma_f32_16x16x32_bf16 v[16:19], v[72:75], a[112:115], v[16:19]
    ds_read_b64_tr_b16 v[104:105], v134 offset:57344
    v_mfma_f32_16x16x32_bf16 v[20:23], v[72:75], a[116:119], v[20:23]
    ds_read_b64_tr_b16 v[106:107], v134 offset:58368
    s_waitcnt lgkmcnt(14)
    v_mfma_f32_16x16x32_bf16 v[24:27], v[76:79], a[112:115], v[24:27]
    ds_read_b64_tr_b16 v[108:109], v135 offset:57344
    buffer_load_dwordx4 a[52:55], v148, s[24:27], s34 offen offset:256 sc1
    v_mfma_f32_16x16x32_bf16 v[28:31], v[76:79], a[116:119], v[28:31]
    ds_read_b64_tr_b16 v[110:111], v135 offset:58368
    s_waitcnt lgkmcnt(14)
    v_mfma_f32_16x16x32_bf16 v[32:35], v[80:83], a[112:115], v[32:35]
    ds_read_b64_tr_b16 v[112:113], v136 offset:57344
    v_mfma_f32_16x16x32_bf16 v[36:39], v[80:83], a[116:119], v[36:39]
    ds_read_b64_tr_b16 v[114:115], v136 offset:58368
    s_waitcnt lgkmcnt(14)
    v_mfma_f32_16x16x32_bf16 v[40:43], v[84:87], a[112:115], v[40:43]
    ds_read_b64_tr_b16 v[116:117], v137 offset:57344
    buffer_load_dwordx4 a[56:59], v148, s[24:27], s34 offen offset:2048 sc1
    v_mfma_f32_16x16x32_bf16 v[44:47], v[84:87], a[116:119], v[44:47]
    ds_read_b64_tr_b16 v[118:119], v137 offset:58368
    s_waitcnt lgkmcnt(14)
    v_mfma_f32_16x16x32_bf16 v[48:51], v[88:91], a[112:115], v[48:51]
    ds_read_b64_tr_b16 v[120:121], v138 offset:57344
    v_mfma_f32_16x16x32_bf16 v[52:55], v[88:91], a[116:119], v[52:55]
    ds_read_b64_tr_b16 v[122:123], v138 offset:58368
    s_waitcnt lgkmcnt(14)
    v_mfma_f32_16x16x32_bf16 v[56:59], v[92:95], a[112:115], v[56:59]
    ds_read_b64_tr_b16 v[124:125], v139 offset:57344
    buffer_load_dwordx4 a[60:63], v148, s[24:27], s34 offen offset:2304 sc1
    s_add_u32 s34, s34, 4096
    s_cmp_eq_u32 s34, 114688
    s_cselect_b32 s34, 0, s34
    v_mfma_f32_16x16x32_bf16 v[60:63], v[92:95], a[116:119], v[60:63]
    ds_read_b64_tr_b16 v[126:127], v139 offset:58368
    s_waitcnt vmcnt(32)
    s_barrier
    s_waitcnt lgkmcnt(14)
    v_mfma_f32_16x16x32_bf16 v[0:3], v[96:99], a[120:123], v[0:3]
    ds_read_b64_tr_b16 v[64:65], v140 offset:0
    v_mfma_f32_16x16x32_bf16 v[4:7], v[96:99], a[124:127], v[4:7]
    ds_read_b64_tr_b16 v[66:67], v140 offset:1024
    s_waitcnt lgkmcnt(14)
    s_add_u32 m0, s35, 32768
    v_mfma_f32_16x16x32_bf16 v[8:11], v[100:103], a[120:123], v[8:11]
    ds_read_b64_tr_b16 v[68:69], v141 offset:0
    buffer_load_dwordx4 v128, s[20:23], s33 offen offset:0 lds
    v_mfma_f32_16x16x32_bf16 v[12:15], v[100:103], a[124:127], v[12:15]
    ds_read_b64_tr_b16 v[70:71], v141 offset:1024
    s_waitcnt lgkmcnt(14)
    v_mfma_f32_16x16x32_bf16 v[16:19], v[104:107], a[120:123], v[16:19]
    ds_read_b64_tr_b16 v[72:73], v142 offset:0
    v_mfma_f32_16x16x32_bf16 v[20:23], v[104:107], a[124:127], v[20:23]
    ds_read_b64_tr_b16 v[74:75], v142 offset:1024
    s_waitcnt lgkmcnt(14)
    v_mfma_f32_16x16x32_bf16 v[24:27], v[108:111], a[120:123], v[24:27]
    ds_read_b64_tr_b16 v[76:77], v143 offset:0
    buffer_load_dwordx4 v129, s[20:23], s33 offen offset:1024 lds
    v_mfma_f32_16x16x32_bf16 v[28:31], v[108:111], a[124:127], v[28:31]
    ds_read_b64_tr_b16 v[78:79], v143 offset:1024
    s_waitcnt lgkmcnt(14)
    v_mfma_f32_16x16x32_bf16 v[32:35], v[112:115], a[120:123], v[32:35]
    ds_read_b64_tr_b16 v[80:81], v144 offset:0
    v_mfma_f32_16x16x32_bf16 v[36:39], v[112:115], a[124:127], v[36:39]
    ds_read_b64_tr_b16 v[82:83], v144 offset:1024
    s_waitcnt lgkmcnt(14)
    v_mfma_f32_16x16x32_bf16 v[40:43], v[116:119], a[120:123], v[40:43]
    ds_read_b64_tr_b16 v[84:85], v145 offset:0
    buffer_load_dwordx4 v130, s[20:23], s33 offen offset:2048 lds
    v_mfma_f32_16x16x32_bf16 v[44:47], v[116:119], a[124:127], v[44:47]
    ds_read_b64_tr_b16 v[86:87], v145 offset:1024
    s_waitcnt lgkmcnt(14)
    v_mfma_f32_16x16x32_bf16 v[48:51], v[120:123], a[120:123], v[48:51]
    ds_read_b64_tr_b16 v[88:89], v146 offset:0
    v_mfma_f32_16x16x32_bf16 v[52:55], v[120:123], a[124:127], v[52:55]
    ds_read_b64_tr_b16 v[90:91], v146 offset:1024
    s_waitcnt lgkmcnt(14)
    v_mfma_f32_16x16x32_bf16 v[56:59], v[124:127], a[120:123], v[56:59]
    ds_read_b64_tr_b16 v[92:93], v147 offset:0
    buffer_load_dwordx4 v131, s[20:23], s33 offen offset:3072 lds
    s_add_u32 s33, s33, 131072
    s_cmp_eq_u32 s33, 3670016
    s_cselect_b32 s33, 0, s33
    v_mfma_f32_16x16x32_bf16 v[60:63], v[124:127], a[124:127], v[60:63]
    ds_read_b64_tr_b16 v[94:95], v147 offset:1024
    s_waitcnt vmcnt(30) lgkmcnt(14)
    v_mfma_f32_16x16x32_bf16 v[0:3], v[64:67], a[0:3], v[0:3]
    ds_read_b64_tr_b16 v[96:97], v140 offset:8192
    v_mfma_f32_16x16x32_bf16 v[4:7], v[64:67], a[4:7], v[4:7]
    ds_read_b64_tr_b16 v[98:99], v140 offset:9216
    s_waitcnt lgkmcnt(14)
    v_mfma_f32_16x16x32_bf16 v[8:11], v[68:71], a[0:3], v[8:11]
    ds_read_b64_tr_b16 v[100:101], v141 offset:8192
    buffer_load_dwordx4 a[64:67], v148, s[24:27], s34 offen offset:0 sc1
    v_mfma_f32_16x16x32_bf16 v[12:15], v[68:71], a[4:7], v[12:15]
    ds_read_b64_tr_b16 v[102:103], v141 offset:9216
    s_waitcnt lgkmcnt(14)
    v_mfma_f32_16x16x32_bf16 v[16:19], v[72:75], a[0:3], v[16:19]
    ds_read_b64_tr_b16 v[104:105], v142 offset:8192
    v_mfma_f32_16x16x32_bf16 v[20:23], v[72:75], a[4:7], v[20:23]
    ds_read_b64_tr_b16 v[106:107], v142 offset:9216
    s_waitcnt lgkmcnt(14)
    v_mfma_f32_16x16x32_bf16 v[24:27], v[76:79], a[0:3], v[24:27]
    ds_read_b64_tr_b16 v[108:109], v143 offset:8192
    buffer_load_dwordx4 a[68:71], v148, s[24:27], s34 offen offset:256 sc1
    v_mfma_f32_16x16x32_bf16 v[28:31], v[76:79], a[4:7], v[28:31]
    ds_read_b64_tr_b16 v[110:111], v143 offset:9216
    s_waitcnt lgkmcnt(14)
    v_mfma_f32_16x16x32_bf16 v[32:35], v[80:83], a[0:3], v[32:35]
    ds_read_b64_tr_b16 v[112:113], v144 offset:8192
    v_mfma_f32_16x16x32_bf16 v[36:39], v[80:83], a[4:7], v[36:39]
    ds_read_b64_tr_b16 v[114:115], v144 offset:9216
    s_waitcnt lgkmcnt(14)
    v_mfma_f32_16x16x32_bf16 v[40:43], v[84:87], a[0:3], v[40:43]
    ds_read_b64_tr_b16 v[116:117], v145 offset:8192
    buffer_load_dwordx4 a[72:75], v148, s[24:27], s34 offen offset:2048 sc1
    v_mfma_f32_16x16x32_bf16 v[44:47], v[84:87], a[4:7], v[44:47]
    ds_read_b64_tr_b16 v[118:119], v145 offset:9216
    s_waitcnt lgkmcnt(14)
    v_mfma_f32_16x16x32_bf16 v[48:51], v[88:91], a[0:3], v[48:51]
    ds_read_b64_tr_b16 v[120:121], v146 offset:8192
    v_mfma_f32_16x16x32_bf16 v[52:55], v[88:91], a[4:7], v[52:55]
    ds_read_b64_tr_b16 v[122:123], v146 offset:9216
    s_waitcnt lgkmcnt(14)
    v_mfma_f32_16x16x32_bf16 v[56:59], v[92:95], a[0:3], v[56:59]
    ds_read_b64_tr_b16 v[124:125], v147 offset:8192
    buffer_load_dwordx4 a[76:79], v148, s[24:27], s34 offen offset:2304 sc1
    s_add_u32 s34, s34, 4096
    s_cmp_eq_u32 s34, 114688
    s_cselect_b32 s34, 0, s34
    v_mfma_f32_16x16x32_bf16 v[60:63], v[92:95], a[4:7], v[60:63]
    ds_read_b64_tr_b16 v[126:127], v147 offset:9216
    s_waitcnt vmcnt(32)
    s_barrier
    s_waitcnt lgkmcnt(14)
    v_mfma_f32_16x16x32_bf16 v[0:3], v[96:99], a[8:11], v[0:3]
    ds_read_b64_tr_b16 v[64:65], v140 offset:16384
    v_mfma_f32_16x16x32_bf16 v[4:7], v[96:99], a[12:15], v[4:7]
    ds_read_b64_tr_b16 v[66:67], v140 offset:17408
    s_waitcnt lgkmcnt(14)
    s_add_u32 m0, s35, 49152
    v_mfma_f32_16x16x32_bf16 v[8:11], v[100:103], a[8:11], v[8:11]
    ds_read_b64_tr_b16 v[68:69], v141 offset:16384
    buffer_load_dwordx4 v128, s[20:23], s33 offen offset:0 lds
    v_mfma_f32_16x16x32_bf16 v[12:15], v[100:103], a[12:15], v[12:15]
    ds_read_b64_tr_b16 v[70:71], v141 offset:17408
    s_waitcnt lgkmcnt(14)
    v_mfma_f32_16x16x32_bf16 v[16:19], v[104:107], a[8:11], v[16:19]
    ds_read_b64_tr_b16 v[72:73], v142 offset:16384
    v_mfma_f32_16x16x32_bf16 v[20:23], v[104:107], a[12:15], v[20:23]
    ds_read_b64_tr_b16 v[74:75], v142 offset:17408
    s_waitcnt lgkmcnt(14)
    v_mfma_f32_16x16x32_bf16 v[24:27], v[108:111], a[8:11], v[24:27]
    ds_read_b64_tr_b16 v[76:77], v143 offset:16384
    buffer_load_dwordx4 v129, s[20:23], s33 offen offset:1024 lds
    v_mfma_f32_16x16x32_bf16 v[28:31], v[108:111], a[12:15], v[28:31]
    ds_read_b64_tr_b16 v[78:79], v143 offset:17408
    s_waitcnt lgkmcnt(14)
    v_mfma_f32_16x16x32_bf16 v[32:35], v[112:115], a[8:11], v[32:35]
    ds_read_b64_tr_b16 v[80:81], v144 offset:16384
    v_mfma_f32_16x16x32_bf16 v[36:39], v[112:115], a[12:15], v[36:39]
    ds_read_b64_tr_b16 v[82:83], v144 offset:17408
    s_waitcnt lgkmcnt(14)
    v_mfma_f32_16x16x32_bf16 v[40:43], v[116:119], a[8:11], v[40:43]
    ds_read_b64_tr_b16 v[84:85], v145 offset:16384
    buffer_load_dwordx4 v130, s[20:23], s33 offen offset:2048 lds
    v_mfma_f32_16x16x32_bf16 v[44:47], v[116:119], a[12:15], v[44:47]
    ds_read_b64_tr_b16 v[86:87], v145 offset:17408
    s_waitcnt lgkmcnt(14)
    v_mfma_f32_16x16x32_bf16 v[48:51], v[120:123], a[8:11], v[48:51]
    ds_read_b64_tr_b16 v[88:89], v146 offset:16384
    s_lshl_b32 s8, 15, s47
    s_andn2_b32 s7, s8, s46
    s_cbranch_scc1 L2_w9
    L2_b9:
    v_mfma_f32_16x16x32_bf16 v[52:55], v[120:123], a[12:15], v[52:55]
    ds_read_b64_tr_b16 v[90:91], v146 offset:17408
    s_waitcnt lgkmcnt(14)
    s_add_u32 s47, s47, 4
    s_and_b32 s47, s47, 15
    v_mfma_f32_16x16x32_bf16 v[56:59], v[124:127], a[8:11], v[56:59]
    ds_read_b64_tr_b16 v[92:93], v147 offset:16384
    buffer_load_dwordx4 v131, s[20:23], s33 offen offset:3072 lds
    s_add_u32 s33, s33, 131072
    s_cmp_eq_u32 s33, 3670016
    s_cselect_b32 s33, 0, s33
    v_mfma_f32_16x16x32_bf16 v[60:63], v[124:127], a[12:15], v[60:63]
    ds_read_b64_tr_b16 v[94:95], v147 offset:17408
    s_waitcnt vmcnt(30) lgkmcnt(14)
    v_mfma_f32_16x16x32_bf16 v[0:3], v[64:67], a[16:19], v[0:3]
    ds_read_b64_tr_b16 v[96:97], v140 offset:24576
    v_mfma_f32_16x16x32_bf16 v[4:7], v[64:67], a[20:23], v[4:7]
    ds_read_b64_tr_b16 v[98:99], v140 offset:25600
    s_waitcnt lgkmcnt(14)
    v_mfma_f32_16x16x32_bf16 v[8:11], v[68:71], a[16:19], v[8:11]
    ds_read_b64_tr_b16 v[100:101], v141 offset:24576
    buffer_load_dwordx4 a[80:83], v148, s[24:27], s34 offen offset:0 sc1
    v_mfma_f32_16x16x32_bf16 v[12:15], v[68:71], a[20:23], v[12:15]
    ds_read_b64_tr_b16 v[102:103], v141 offset:25600
    s_waitcnt lgkmcnt(14)
    v_mfma_f32_16x16x32_bf16 v[16:19], v[72:75], a[16:19], v[16:19]
    ds_read_b64_tr_b16 v[104:105], v142 offset:24576
    v_mfma_f32_16x16x32_bf16 v[20:23], v[72:75], a[20:23], v[20:23]
    ds_read_b64_tr_b16 v[106:107], v142 offset:25600
    s_waitcnt lgkmcnt(14)
    v_mfma_f32_16x16x32_bf16 v[24:27], v[76:79], a[16:19], v[24:27]
    ds_read_b64_tr_b16 v[108:109], v143 offset:24576
    buffer_load_dwordx4 a[84:87], v148, s[24:27], s34 offen offset:256 sc1
    v_mfma_f32_16x16x32_bf16 v[28:31], v[76:79], a[20:23], v[28:31]
    ds_read_b64_tr_b16 v[110:111], v143 offset:25600
    s_waitcnt lgkmcnt(14)
    v_mfma_f32_16x16x32_bf16 v[32:35], v[80:83], a[16:19], v[32:35]
    ds_read_b64_tr_b16 v[112:113], v144 offset:24576
    v_mfma_f32_16x16x32_bf16 v[36:39], v[80:83], a[20:23], v[36:39]
    ds_read_b64_tr_b16 v[114:115], v144 offset:25600
    s_waitcnt lgkmcnt(14)
    v_mfma_f32_16x16x32_bf16 v[40:43], v[84:87], a[16:19], v[40:43]
    ds_read_b64_tr_b16 v[116:117], v145 offset:24576
    buffer_load_dwordx4 a[88:91], v148, s[24:27], s34 offen offset:2048 sc1
    v_mfma_f32_16x16x32_bf16 v[44:47], v[84:87], a[20:23], v[44:47]
    ds_read_b64_tr_b16 v[118:119], v145 offset:25600
    s_waitcnt lgkmcnt(14)
    v_mfma_f32_16x16x32_bf16 v[48:51], v[88:91], a[16:19], v[48:51]
    ds_read_b64_tr_b16 v[120:121], v146 offset:24576
    v_mfma_f32_16x16x32_bf16 v[52:55], v[88:91], a[20:23], v[52:55]
    ds_read_b64_tr_b16 v[122:123], v146 offset:25600
    s_waitcnt lgkmcnt(14)
    v_mfma_f32_16x16x32_bf16 v[56:59], v[92:95], a[16:19], v[56:59]
    ds_read_b64_tr_b16 v[124:125], v147 offset:24576
    buffer_load_dwordx4 a[92:95], v148, s[24:27], s34 offen offset:2304 sc1
    s_add_u32 s34, s34, 4096
    s_cmp_eq_u32 s34, 114688
    s_cselect_b32 s34, 0, s34
    v_mfma_f32_16x16x32_bf16 v[60:63], v[92:95], a[20:23], v[60:63]
    ds_read_b64_tr_b16 v[126:127], v147 offset:25600
    s_waitcnt vmcnt(32)
    s_barrier
    s_waitcnt lgkmcnt(14)
    v_mfma_f32_16x16x32_bf16 v[0:3], v[96:99], a[24:27], v[0:3]
    ds_read_b64_tr_b16 v[64:65], v140 offset:32768
    v_mfma_f32_16x16x32_bf16 v[4:7], v[96:99], a[28:31], v[4:7]
    ds_read_b64_tr_b16 v[66:67], v140 offset:33792
    s_waitcnt lgkmcnt(14)
    s_add_u32 m0, s35, 98304
    v_mfma_f32_16x16x32_bf16 v[8:11], v[100:103], a[24:27], v[8:11]
    ds_read_b64_tr_b16 v[68:69], v141 offset:32768
    buffer_load_dwordx4 v128, s[20:23], s33 offen offset:0 lds
    v_mfma_f32_16x16x32_bf16 v[12:15], v[100:103], a[28:31], v[12:15]
    ds_read_b64_tr_b16 v[70:71], v141 offset:33792
    s_waitcnt lgkmcnt(14)
    v_mfma_f32_16x16x32_bf16 v[16:19], v[104:107], a[24:27], v[16:19]
    ds_read_b64_tr_b16 v[72:73], v142 offset:32768
    v_mfma_f32_16x16x32_bf16 v[20:23], v[104:107], a[28:31], v[20:23]
    ds_read_b64_tr_b16 v[74:75], v142 offset:33792
    s_waitcnt lgkmcnt(14)
    v_mfma_f32_16x16x32_bf16 v[24:27], v[108:111], a[24:27], v[24:27]
    ds_read_b64_tr_b16 v[76:77], v143 offset:32768
    buffer_load_dwordx4 v129, s[20:23], s33 offen offset:1024 lds
    v_mfma_f32_16x16x32_bf16 v[28:31], v[108:111], a[28:31], v[28:31]
    ds_read_b64_tr_b16 v[78:79], v143 offset:33792
    s_waitcnt lgkmcnt(14)
    v_mfma_f32_16x16x32_bf16 v[32:35], v[112:115], a[24:27], v[32:35]
    ds_read_b64_tr_b16 v[80:81], v144 offset:32768
    v_mfma_f32_16x16x32_bf16 v[36:39], v[112:115], a[28:31], v[36:39]
    ds_read_b64_tr_b16 v[82:83], v144 offset:33792
    s_waitcnt lgkmcnt(14)
    v_mfma_f32_16x16x32_bf16 v[40:43], v[116:119], a[24:27], v[40:43]
    ds_read_b64_tr_b16 v[84:85], v145 offset:32768
    buffer_load_dwordx4 v130, s[20:23], s33 offen offset:2048 lds
    v_mfma_f32_16x16x32_bf16 v[44:47], v[116:119], a[28:31], v[44:47]
    ds_read_b64_tr_b16 v[86:87], v145 offset:33792
    s_waitcnt lgkmcnt(14)
    v_mfma_f32_16x16x32_bf16 v[48:51], v[120:123], a[24:27], v[48:51]
    ds_read_b64_tr_b16 v[88:89], v146 offset:32768
    v_mfma_f32_16x16x32_bf16 v[52:55], v[120:123], a[28:31], v[52:55]
    ds_read_b64_tr_b16 v[90:91], v146 offset:33792
    s_waitcnt lgkmcnt(14)
    v_mfma_f32_16x16x32_bf16 v[56:59], v[124:127], a[24:27], v[56:59]
    ds_read_b64_tr_b16 v[92:93], v147 offset:32768
    buffer_load_dwordx4 v131, s[20:23], s33 offen offset:3072 lds
    s_add_u32 s33, s33, 131072
    s_cmp_eq_u32 s33, 3670016
    s_cselect_b32 s33, 0, s33
    v_mfma_f32_16x16x32_bf16 v[60:63], v[124:127], a[28:31], v[60:63]
    ds_read_b64_tr_b16 v[94:95], v147 offset:33792
    s_waitcnt vmcnt(30) lgkmcnt(14)
    v_mfma_f32_16x16x32_bf16 v[0:3], v[64:67], a[32:35], v[0:3]
    ds_read_b64_tr_b16 v[96:97], v140 offset:40960
    v_mfma_f32_16x16x32_bf16 v[4:7], v[64:67], a[36:39], v[4:7]
    ds_read_b64_tr_b16 v[98:99], v140 offset:41984
    s_waitcnt lgkmcnt(14)
    v_mfma_f32_16x16x32_bf16 v[8:11], v[68:71], a[32:35], v[8:11]
    ds_read_b64_tr_b16 v[100:101], v141 offset:40960
    buffer_load_dwordx4 a[96:99], v148, s[24:27], s34 offen offset:0 sc1
    v_mfma_f32_16x16x32_bf16 v[12:15], v[68:71], a[36:39], v[12:15]
    ds_read_b64_tr_b16 v[102:103], v141 offset:41984
    s_waitcnt lgkmcnt(14)
    v_mfma_f32_16x16x32_bf16 v[16:19], v[72:75], a[32:35], v[16:19]
    ds_read_b64_tr_b16 v[104:105], v142 offset:40960
    v_mfma_f32_16x16x32_bf16 v[20:23], v[72:75], a[36:39], v[20:23]
    ds_read_b64_tr_b16 v[106:107], v142 offset:41984
    s_waitcnt lgkmcnt(14)
    v_mfma_f32_16x16x32_bf16 v[24:27], v[76:79], a[32:35], v[24:27]
    ds_read_b64_tr_b16 v[108:109], v143 offset:40960
    buffer_load_dwordx4 a[100:103], v148, s[24:27], s34 offen offset:256 sc1
    v_mfma_f32_16x16x32_bf16 v[28:31], v[76:79], a[36:39], v[28:31]
    ds_read_b64_tr_b16 v[110:111], v143 offset:41984
    s_waitcnt lgkmcnt(14)
    v_mfma_f32_16x16x32_bf16 v[32:35], v[80:83], a[32:35], v[32:35]
    ds_read_b64_tr_b16 v[112:113], v144 offset:40960
    v_mfma_f32_16x16x32_bf16 v[36:39], v[80:83], a[36:39], v[36:39]
    ds_read_b64_tr_b16 v[114:115], v144 offset:41984
    s_waitcnt lgkmcnt(14)
    v_mfma_f32_16x16x32_bf16 v[40:43], v[84:87], a[32:35], v[40:43]
    ds_read_b64_tr_b16 v[116:117], v145 offset:40960
    buffer_load_dwordx4 a[104:107], v148, s[24:27], s34 offen offset:2048 sc1
    v_mfma_f32_16x16x32_bf16 v[44:47], v[84:87], a[36:39], v[44:47]
    ds_read_b64_tr_b16 v[118:119], v145 offset:41984
    s_waitcnt lgkmcnt(14)
    v_mfma_f32_16x16x32_bf16 v[48:51], v[88:91], a[32:35], v[48:51]
    ds_read_b64_tr_b16 v[120:121], v146 offset:40960
    v_mfma_f32_16x16x32_bf16 v[52:55], v[88:91], a[36:39], v[52:55]
    ds_read_b64_tr_b16 v[122:123], v146 offset:41984
    s_waitcnt lgkmcnt(14)
    v_mfma_f32_16x16x32_bf16 v[56:59], v[92:95], a[32:35], v[56:59]
    ds_read_b64_tr_b16 v[124:125], v147 offset:40960
    buffer_load_dwordx4 a[108:111], v148, s[24:27], s34 offen offset:2304 sc1
    s_add_u32 s34, s34, 4096
    s_cmp_eq_u32 s34, 114688
    s_cselect_b32 s34, 0, s34
    v_mfma_f32_16x16x32_bf16 v[60:63], v[92:95], a[36:39], v[60:63]
    ds_read_b64_tr_b16 v[126:127], v147 offset:41984
    s_waitcnt vmcnt(32)
    s_barrier
    s_waitcnt lgkmcnt(14)
    v_mfma_f32_16x16x32_bf16 v[0:3], v[96:99], a[40:43], v[0:3]
    ds_read_b64_tr_b16 v[64:65], v140 offset:49152
    v_mfma_f32_16x16x32_bf16 v[4:7], v[96:99], a[44:47], v[4:7]
    ds_read_b64_tr_b16 v[66:67], v140 offset:50176
    s_waitcnt lgkmcnt(14)
    s_add_u32 m0, s35, 114688
    v_mfma_f32_16x16x32_bf16 v[8:11], v[100:103], a[40:43], v[8:11]
    ds_read_b64_tr_b16 v[68:69], v141 offset:49152
    buffer_load_dwordx4 v128, s[20:23], s33 offen offset:0 lds
    v_mfma_f32_16x16x32_bf16 v[12:15], v[100:103], a[44:47], v[12:15]
    ds_read_b64_tr_b16 v[70:71], v141 offset:50176
    s_waitcnt lgkmcnt(14)
    v_mfma_f32_16x16x32_bf16 v[16:19], v[104:107], a[40:43], v[16:19]
    ds_read_b64_tr_b16 v[72:73], v142 offset:49152
    v_mfma_f32_16x16x32_bf16 v[20:23], v[104:107], a[44:47], v[20:23]
    ds_read_b64_tr_b16 v[74:75], v142 offset:50176
    s_waitcnt lgkmcnt(14)
    v_mfma_f32_16x16x32_bf16 v[24:27], v[108:111], a[40:43], v[24:27]
    ds_read_b64_tr_b16 v[76:77], v143 offset:49152
    buffer_load_dwordx4 v129, s[20:23], s33 offen offset:1024 lds
    v_mfma_f32_16x16x32_bf16 v[28:31], v[108:111], a[44:47], v[28:31]
    ds_read_b64_tr_b16 v[78:79], v143 offset:50176
    s_waitcnt lgkmcnt(14)
    v_mfma_f32_16x16x32_bf16 v[32:35], v[112:115], a[40:43], v[32:35]
    ds_read_b64_tr_b16 v[80:81], v144 offset:49152
    v_mfma_f32_16x16x32_bf16 v[36:39], v[112:115], a[44:47], v[36:39]
    ds_read_b64_tr_b16 v[82:83], v144 offset:50176
    s_waitcnt lgkmcnt(14)
    v_mfma_f32_16x16x32_bf16 v[40:43], v[116:119], a[40:43], v[40:43]
    ds_read_b64_tr_b16 v[84:85], v145 offset:49152
    buffer_load_dwordx4 v130, s[20:23], s33 offen offset:2048 lds
    v_mfma_f32_16x16x32_bf16 v[44:47], v[116:119], a[44:47], v[44:47]
    ds_read_b64_tr_b16 v[86:87], v145 offset:50176
    s_waitcnt lgkmcnt(14)
    v_mfma_f32_16x16x32_bf16 v[48:51], v[120:123], a[40:43], v[48:51]
    ds_read_b64_tr_b16 v[88:89], v146 offset:49152
    v_mfma_f32_16x16x32_bf16 v[52:55], v[120:123], a[44:47], v[52:55]
    ds_read_b64_tr_b16 v[90:91], v146 offset:50176
    s_waitcnt lgkmcnt(14)
    v_mfma_f32_16x16x32_bf16 v[56:59], v[124:127], a[40:43], v[56:59]
    ds_read_b64_tr_b16 v[92:93], v147 offset:49152
    buffer_load_dwordx4 v131, s[20:23], s33 offen offset:3072 lds
    s_add_u32 s33, s33, 131072
    s_cmp_eq_u32 s33, 3670016
    s_cselect_b32 s33, 0, s33
    v_mfma_f32_16x16x32_bf16 v[60:63], v[124:127], a[44:47], v[60:63]
    ds_read_b64_tr_b16 v[94:95], v147 offset:50176
    s_waitcnt vmcnt(30) lgkmcnt(14)
    v_mfma_f32_16x16x32_bf16 v[0:3], v[64:67], a[48:51], v[0:3]
    ds_read_b64_tr_b16 v[96:97], v140 offset:57344
    v_mfma_f32_16x16x32_bf16 v[4:7], v[64:67], a[52:55], v[4:7]
    ds_read_b64_tr_b16 v[98:99], v140 offset:58368
    s_waitcnt lgkmcnt(14)
    v_mfma_f32_16x16x32_bf16 v[8:11], v[68:71], a[48:51], v[8:11]
    ds_read_b64_tr_b16 v[100:101], v141 offset:57344
    buffer_load_dwordx4 a[112:115], v148, s[24:27], s34 offen offset:0 sc1
    v_mfma_f32_16x16x32_bf16 v[12:15], v[68:71], a[52:55], v[12:15]
    ds_read_b64_tr_b16 v[102:103], v141 offset:58368
    s_waitcnt lgkmcnt(14)
    v_mfma_f32_16x16x32_bf16 v[16:19], v[72:75], a[48:51], v[16:19]
    ds_read_b64_tr_b16 v[104:105], v142 offset:57344
    v_mfma_f32_16x16x32_bf16 v[20:23], v[72:75], a[52:55], v[20:23]
    ds_read_b64_tr_b16 v[106:107], v142 offset:58368
    s_waitcnt lgkmcnt(14)
    v_mfma_f32_16x16x32_bf16 v[24:27], v[76:79], a[48:51], v[24:27]
    ds_read_b64_tr_b16 v[108:109], v143 offset:57344
    buffer_load_dwordx4 a[116:119], v148, s[24:27], s34 offen offset:256 sc1
    v_mfma_f32_16x16x32_bf16 v[28:31], v[76:79], a[52:55], v[28:31]
    ds_read_b64_tr_b16 v[110:111], v143 offset:58368
    s_waitcnt lgkmcnt(14)
    v_mfma_f32_16x16x32_bf16 v[32:35], v[80:83], a[48:51], v[32:35]
    ds_read_b64_tr_b16 v[112:113], v144 offset:57344
    v_mfma_f32_16x16x32_bf16 v[36:39], v[80:83], a[52:55], v[36:39]
    ds_read_b64_tr_b16 v[114:115], v144 offset:58368
    s_waitcnt lgkmcnt(14)
    v_mfma_f32_16x16x32_bf16 v[40:43], v[84:87], a[48:51], v[40:43]
    ds_read_b64_tr_b16 v[116:117], v145 offset:57344
    buffer_load_dwordx4 a[120:123], v148, s[24:27], s34 offen offset:2048 sc1
    v_mfma_f32_16x16x32_bf16 v[44:47], v[84:87], a[52:55], v[44:47]
    ds_read_b64_tr_b16 v[118:119], v145 offset:58368
    s_waitcnt lgkmcnt(14)
    v_mfma_f32_16x16x32_bf16 v[48:51], v[88:91], a[48:51], v[48:51]
    ds_read_b64_tr_b16 v[120:121], v146 offset:57344
    v_mfma_f32_16x16x32_bf16 v[52:55], v[88:91], a[52:55], v[52:55]
    ds_read_b64_tr_b16 v[122:123], v146 offset:58368
    s_waitcnt lgkmcnt(14)
    v_mfma_f32_16x16x32_bf16 v[56:59], v[92:95], a[48:51], v[56:59]
    ds_read_b64_tr_b16 v[124:125], v147 offset:57344
    buffer_load_dwordx4 a[124:127], v148, s[24:27], s34 offen offset:2304 sc1
    s_add_u32 s34, s34, 4096
    s_cmp_eq_u32 s34, 114688
    s_cselect_b32 s34, 0, s34
    v_mfma_f32_16x16x32_bf16 v[60:63], v[92:95], a[52:55], v[60:63]
    ds_read_b64_tr_b16 v[126:127], v147 offset:58368
    s_add_u32 s38, s38, 1
    s_cmp_lt_u32 s38, 2
    s_cbranch_scc1 L2_loop
    s_waitcnt vmcnt(32)
    s_barrier
    s_waitcnt lgkmcnt(14)
    v_mfma_f32_16x16x32_bf16 v[0:3], v[96:99], a[56:59], v[0:3]
    ds_read_b64_tr_b16 v[64:65], v132 offset:0
    v_mfma_f32_16x16x32_bf16 v[4:7], v[96:99], a[60:63], v[4:7]
    ds_read_b64_tr_b16 v[66:67], v132 offset:1024
    s_waitcnt lgkmcnt(14)
    s_add_u32 m0, s35, 131072
    v_mfma_f32_16x16x32_bf16 v[8:11], v[100:103], a[56:59], v[8:11]
    ds_read_b64_tr_b16 v[68:69], v133 offset:0
    buffer_load_dwordx4 v128, s[20:23], s33 offen offset:0 lds
    v_mfma_f32_16x16x32_bf16 v[12:15], v[100:103], a[60:63], v[12:15]
    ds_read_b64_tr_b16 v[70:71], v133 offset:1024
    s_waitcnt lgkmcnt(14)
    v_mfma_f32_16x16x32_bf16 v[16:19], v[104:107], a[56:59], v[16:19]
    ds_read_b64_tr_b16 v[72:73], v134 offset:0
    v_mfma_f32_16x16x32_bf16 v[20:23], v[104:107], a[60:63], v[20:23]
    ds_read_b64_tr_b16 v[74:75], v134 offset:1024
    s_waitcnt lgkmcnt(14)
    v_mfma_f32_16x16x32_bf16 v[24:27], v[108:111], a[56:59], v[24:27]
    ds_read_b64_tr_b16 v[76:77], v135 offset:0
    buffer_load_dwordx4 v129, s[20:23], s33 offen offset:1024 lds
    v_mfma_f32_16x16x32_bf16 v[28:31], v[108:111], a[60:63], v[28:31]
    ds_read_b64_tr_b16 v[78:79], v135 offset:1024
    s_waitcnt lgkmcnt(14)
    v_mfma_f32_16x16x32_bf16 v[32:35], v[112:115], a[56:59], v[32:35]
    ds_read_b64_tr_b16 v[80:81], v136 offset:0
    v_mfma_f32_16x16x32_bf16 v[36:39], v[112:115], a[60:63], v[36:39]
    ds_read_b64_tr_b16 v[82:83], v136 offset:1024
    s_waitcnt lgkmcnt(14)
    v_mfma_f32_16x16x32_bf16 v[40:43], v[116:119], a[56:59], v[40:43]
    ds_read_b64_tr_b16 v[84:85], v137 offset:0
    buffer_load_dwordx4 v130, s[20:23], s33 offen offset:2048 lds
    v_mfma_f32_16x16x32_bf16 v[44:47], v[116:119], a[60:63], v[44:47]
    ds_read_b64_tr_b16 v[86:87], v137 offset:1024
    s_waitcnt lgkmcnt(14)
    v_mfma_f32_16x16x32_bf16 v[48:51], v[120:123], a[56:59], v[48:51]
    ds_read_b64_tr_b16 v[88:89], v138 offset:0
    v_mfma_f32_16x16x32_bf16 v[52:55], v[120:123], a[60:63], v[52:55]
    ds_read_b64_tr_b16 v[90:91], v138 offset:1024
    s_waitcnt lgkmcnt(14)
    v_mfma_f32_16x16x32_bf16 v[56:59], v[124:127], a[56:59], v[56:59]
    ds_read_b64_tr_b16 v[92:93], v139 offset:0
    buffer_load_dwordx4 v131, s[20:23], s33 offen offset:3072 lds
    s_add_u32 s33, s33, 131072
    s_cmp_eq_u32 s33, 3670016
    s_cselect_b32 s33, 0, s33
    v_mfma_f32_16x16x32_bf16 v[60:63], v[124:127], a[60:63], v[60:63]
    ds_read_b64_tr_b16 v[94:95], v139 offset:1024
    s_waitcnt vmcnt(30) lgkmcnt(14)
    v_mfma_f32_16x16x32_bf16 v[0:3], v[64:67], a[64:67], v[0:3]
    ds_read_b64_tr_b16 v[96:97], v132 offset:8192
    v_mfma_f32_16x16x32_bf16 v[4:7], v[64:67], a[68:71], v[4:7]
    ds_read_b64_tr_b16 v[98:99], v132 offset:9216
    s_waitcnt lgkmcnt(14)
    v_mfma_f32_16x16x32_bf16 v[8:11], v[68:71], a[64:67], v[8:11]
    ds_read_b64_tr_b16 v[100:101], v133 offset:8192
    buffer_load_dwordx4 a[0:3], v148, s[24:27], s34 offen offset:0 sc1
    v_mfma_f32_16x16x32_bf16 v[12:15], v[68:71], a[68:71], v[12:15]
    ds_read_b64_tr_b16 v[102:103], v133 offset:9216
    s_waitcnt lgkmcnt(14)
    v_mfma_f32_16x16x32_bf16 v[16:19], v[72:75], a[64:67], v[16:19]
    ds_read_b64_tr_b16 v[104:105], v134 offset:8192
    v_mfma_f32_16x16x32_bf16 v[20:23], v[72:75], a[68:71], v[20:23]
    ds_read_b64_tr_b16 v[106:107], v134 offset:9216
    s_waitcnt lgkmcnt(14)
    v_mfma_f32_16x16x32_bf16 v[24:27], v[76:79], a[64:67], v[24:27]
    ds_read_b64_tr_b16 v[108:109], v135 offset:8192
    buffer_load_dwordx4 a[4:7], v148, s[24:27], s34 offen offset:256 sc1
    v_mfma_f32_16x16x32_bf16 v[28:31], v[76:79], a[68:71], v[28:31]
    ds_read_b64_tr_b16 v[110:111], v135 offset:9216
    s_waitcnt lgkmcnt(14)
    v_mfma_f32_16x16x32_bf16 v[32:35], v[80:83], a[64:67], v[32:35]
    ds_read_b64_tr_b16 v[112:113], v136 offset:8192
    v_mfma_f32_16x16x32_bf16 v[36:39], v[80:83], a[68:71], v[36:39]
    ds_read_b64_tr_b16 v[114:115], v136 offset:9216
    s_waitcnt lgkmcnt(14)
    v_mfma_f32_16x16x32_bf16 v[40:43], v[84:87], a[64:67], v[40:43]
    ds_read_b64_tr_b16 v[116:117], v137 offset:8192
    buffer_load_dwordx4 a[8:11], v148, s[24:27], s34 offen offset:2048 sc1
    v_mfma_f32_16x16x32_bf16 v[44:47], v[84:87], a[68:71], v[44:47]
    ds_read_b64_tr_b16 v[118:119], v137 offset:9216
    s_waitcnt lgkmcnt(14)
    v_mfma_f32_16x16x32_bf16 v[48:51], v[88:91], a[64:67], v[48:51]
    ds_read_b64_tr_b16 v[120:121], v138 offset:8192
    v_mfma_f32_16x16x32_bf16 v[52:55], v[88:91], a[68:71], v[52:55]
    ds_read_b64_tr_b16 v[122:123], v138 offset:9216
    s_waitcnt lgkmcnt(14)
    v_mfma_f32_16x16x32_bf16 v[56:59], v[92:95], a[64:67], v[56:59]
    ds_read_b64_tr_b16 v[124:125], v139 offset:8192
    buffer_load_dwordx4 a[12:15], v148, s[24:27], s34 offen offset:2304 sc1
    s_add_u32 s34, s34, 4096
    s_cmp_eq_u32 s34, 114688
    s_cselect_b32 s34, 0, s34
    v_mfma_f32_16x16x32_bf16 v[60:63], v[92:95], a[68:71], v[60:63]
    ds_read_b64_tr_b16 v[126:127], v139 offset:9216
    s_waitcnt vmcnt(32)
    s_barrier
    s_waitcnt lgkmcnt(14)
    v_mfma_f32_16x16x32_bf16 v[0:3], v[96:99], a[72:75], v[0:3]
    ds_read_b64_tr_b16 v[64:65], v132 offset:16384
    v_mfma_f32_16x16x32_bf16 v[4:7], v[96:99], a[76:79], v[4:7]
    ds_read_b64_tr_b16 v[66:67], v132 offset:17408
    s_waitcnt lgkmcnt(14)
    s_add_u32 m0, s35, 147456
    v_mfma_f32_16x16x32_bf16 v[8:11], v[100:103], a[72:75], v[8:11]
    ds_read_b64_tr_b16 v[68:69], v133 offset:16384
    buffer_load_dwordx4 v128, s[20:23], s33 offen offset:0 lds
    v_mfma_f32_16x16x32_bf16 v[12:15], v[100:103], a[76:79], v[12:15]
    ds_read_b64_tr_b16 v[70:71], v133 offset:17408
    s_waitcnt lgkmcnt(14)
    v_mfma_f32_16x16x32_bf16 v[16:19], v[104:107], a[72:75], v[16:19]
    ds_read_b64_tr_b16 v[72:73], v134 offset:16384
    v_mfma_f32_16x16x32_bf16 v[20:23], v[104:107], a[76:79], v[20:23]
    ds_read_b64_tr_b16 v[74:75], v134 offset:17408
    s_waitcnt lgkmcnt(14)
    v_mfma_f32_16x16x32_bf16 v[24:27], v[108:111], a[72:75], v[24:27]
    ds_read_b64_tr_b16 v[76:77], v135 offset:16384
    buffer_load_dwordx4 v129, s[20:23], s33 offen offset:1024 lds
    v_mfma_f32_16x16x32_bf16 v[28:31], v[108:111], a[76:79], v[28:31]
    ds_read_b64_tr_b16 v[78:79], v135 offset:17408
    s_waitcnt lgkmcnt(14)
    v_mfma_f32_16x16x32_bf16 v[32:35], v[112:115], a[72:75], v[32:35]
    ds_read_b64_tr_b16 v[80:81], v136 offset:16384
    v_mfma_f32_16x16x32_bf16 v[36:39], v[112:115], a[76:79], v[36:39]
    ds_read_b64_tr_b16 v[82:83], v136 offset:17408
    s_waitcnt lgkmcnt(14)
    v_mfma_f32_16x16x32_bf16 v[40:43], v[116:119], a[72:75], v[40:43]
    ds_read_b64_tr_b16 v[84:85], v137 offset:16384
    buffer_load_dwordx4 v130, s[20:23], s33 offen offset:2048 lds
    v_mfma_f32_16x16x32_bf16 v[44:47], v[116:119], a[76:79], v[44:47]
    ds_read_b64_tr_b16 v[86:87], v137 offset:17408
    s_waitcnt lgkmcnt(14)
    v_mfma_f32_16x16x32_bf16 v[48:51], v[120:123], a[72:75], v[48:51]
    ds_read_b64_tr_b16 v[88:89], v138 offset:16384
    v_mfma_f32_16x16x32_bf16 v[52:55], v[120:123], a[76:79], v[52:55]
    ds_read_b64_tr_b16 v[90:91], v138 offset:17408
    s_waitcnt lgkmcnt(14)
    v_mfma_f32_16x16x32_bf16 v[56:59], v[124:127], a[72:75], v[56:59]
    ds_read_b64_tr_b16 v[92:93], v139 offset:16384
    buffer_load_dwordx4 v131, s[20:23], s33 offen offset:3072 lds
    s_add_u32 s33, s33, 131072
    s_cmp_eq_u32 s33, 3670016
    s_cselect_b32 s33, 0, s33
    v_mfma_f32_16x16x32_bf16 v[60:63], v[124:127], a[76:79], v[60:63]
    ds_read_b64_tr_b16 v[94:95], v139 offset:17408
    s_waitcnt vmcnt(30) lgkmcnt(14)
    v_mfma_f32_16x16x32_bf16 v[0:3], v[64:67], a[80:83], v[0:3]
    ds_read_b64_tr_b16 v[96:97], v132 offset:24576
    v_mfma_f32_16x16x32_bf16 v[4:7], v[64:67], a[84:87], v[4:7]
    ds_read_b64_tr_b16 v[98:99], v132 offset:25600
    s_waitcnt lgkmcnt(14)
    v_mfma_f32_16x16x32_bf16 v[8:11], v[68:71], a[80:83], v[8:11]
    ds_read_b64_tr_b16 v[100:101], v133 offset:24576
    buffer_load_dwordx4 a[16:19], v148, s[24:27], s34 offen offset:0 sc1
    v_mfma_f32_16x16x32_bf16 v[12:15], v[68:71], a[84:87], v[12:15]
    ds_read_b64_tr_b16 v[102:103], v133 offset:25600
    s_waitcnt lgkmcnt(14)
    v_mfma_f32_16x16x32_bf16 v[16:19], v[72:75], a[80:83], v[16:19]
    ds_read_b64_tr_b16 v[104:105], v134 offset:24576
    v_mfma_f32_16x16x32_bf16 v[20:23], v[72:75], a[84:87], v[20:23]
    ds_read_b64_tr_b16 v[106:107], v134 offset:25600
    s_waitcnt lgkmcnt(14)
    v_mfma_f32_16x16x32_bf16 v[24:27], v[76:79], a[80:83], v[24:27]
    ds_read_b64_tr_b16 v[108:109], v135 offset:24576
    buffer_load_dwordx4 a[20:23], v148, s[24:27], s34 offen offset:256 sc1
    v_mfma_f32_16x16x32_bf16 v[28:31], v[76:79], a[84:87], v[28:31]
    ds_read_b64_tr_b16 v[110:111], v135 offset:25600
    s_waitcnt lgkmcnt(14)
    v_mfma_f32_16x16x32_bf16 v[32:35], v[80:83], a[80:83], v[32:35]
    ds_read_b64_tr_b16 v[112:113], v136 offset:24576
    v_mfma_f32_16x16x32_bf16 v[36:39], v[80:83], a[84:87], v[36:39]
    ds_read_b64_tr_b16 v[114:115], v136 offset:25600
    s_waitcnt lgkmcnt(14)
    v_mfma_f32_16x16x32_bf16 v[40:43], v[84:87], a[80:83], v[40:43]
    ds_read_b64_tr_b16 v[116:117], v137 offset:24576
    buffer_load_dwordx4 a[24:27], v148, s[24:27], s34 offen offset:2048 sc1
    v_mfma_f32_16x16x32_bf16 v[44:47], v[84:87], a[84:87], v[44:47]
    ds_read_b64_tr_b16 v[118:119], v137 offset:25600
    s_waitcnt lgkmcnt(14)
    v_mfma_f32_16x16x32_bf16 v[48:51], v[88:91], a[80:83], v[48:51]
    ds_read_b64_tr_b16 v[120:121], v138 offset:24576
    v_mfma_f32_16x16x32_bf16 v[52:55], v[88:91], a[84:87], v[52:55]
    ds_read_b64_tr_b16 v[122:123], v138 offset:25600
    s_waitcnt lgkmcnt(14)
    v_mfma_f32_16x16x32_bf16 v[56:59], v[92:95], a[80:83], v[56:59]
    ds_read_b64_tr_b16 v[124:125], v139 offset:24576
    buffer_load_dwordx4 a[28:31], v148, s[24:27], s34 offen offset:2304 sc1
    s_add_u32 s34, s34, 4096
    s_cmp_eq_u32 s34, 114688
    s_cselect_b32 s34, 0, s34
    v_mfma_f32_16x16x32_bf16 v[60:63], v[92:95], a[84:87], v[60:63]
    ds_read_b64_tr_b16 v[126:127], v139 offset:25600
L2_done:
    s_waitcnt vmcnt(12)
    s_barrier
    s_waitcnt lgkmcnt(14)
    v_mfma_f32_16x16x32_bf16 v[0:3], v[96:99], a[88:91], v[0:3]
    ds_read_b64_tr_b16 v[64:65], v132 offset:32768
    v_mfma_f32_16x16x32_bf16 v[4:7], v[96:99], a[92:95], v[4:7]
    ds_read_b64_tr_b16 v[66:67], v132 offset:33792
    s_waitcnt lgkmcnt(14)
    v_mfma_f32_16x16x32_bf16 v[8:11], v[100:103], a[88:91], v[8:11]
    ds_read_b64_tr_b16 v[68:69], v133 offset:32768
    buffer_load_dwordx4 a[32:35], v148, s[24:27], s34 offen offset:0 sc1
    v_mfma_f32_16x16x32_bf16 v[12:15], v[100:103], a[92:95], v[12:15]
    ds_read_b64_tr_b16 v[70:71], v133 offset:33792
    s_waitcnt lgkmcnt(14)
    v_mfma_f32_16x16x32_bf16 v[16:19], v[104:107], a[88:91], v[16:19]
    ds_read_b64_tr_b16 v[72:73], v134 offset:32768
    v_mfma_f32_16x16x32_bf16 v[20:23], v[104:107], a[92:95], v[20:23]
    ds_read_b64_tr_b16 v[74:75], v134 offset:33792
    s_waitcnt lgkmcnt(14)
    v_mfma_f32_16x16x32_bf16 v[24:27], v[108:111], a[88:91], v[24:27]
    ds_read_b64_tr_b16 v[76:77], v135 offset:32768
    buffer_load_dwordx4 a[36:39], v148, s[24:27], s34 offen offset:256 sc1
    v_mfma_f32_16x16x32_bf16 v[28:31], v[108:111], a[92:95], v[28:31]
    ds_read_b64_tr_b16 v[78:79], v135 offset:33792
    s_waitcnt lgkmcnt(14)
    v_mfma_f32_16x16x32_bf16 v[32:35], v[112:115], a[88:91], v[32:35]
    ds_read_b64_tr_b16 v[80:81], v132 offset:40960
    v_mfma_f32_16x16x32_bf16 v[36:39], v[112:115], a[92:95], v[36:39]
    ds_read_b64_tr_b16 v[82:83], v132 offset:41984
    s_waitcnt lgkmcnt(14)
    v_mfma_f32_16x16x32_bf16 v[40:43], v[116:119], a[88:91], v[40:43]
    ds_read_b64_tr_b16 v[84:85], v133 offset:40960
    buffer_load_dwordx4 a[40:43], v148, s[24:27], s34 offen offset:2048 sc1
    v_mfma_f32_16x16x32_bf16 v[44:47], v[116:119], a[92:95], v[44:47]
    ds_read_b64_tr_b16 v[86:87], v133 offset:41984
    s_waitcnt lgkmcnt(14)
    v_mfma_f32_16x16x32_bf16 v[48:51], v[120:123], a[88:91], v[48:51]
    ds_read_b64_tr_b16 v[88:89], v134 offset:40960
    v_mfma_f32_16x16x32_bf16 v[52:55], v[120:123], a[92:95], v[52:55]
    ds_read_b64_tr_b16 v[90:91], v134 offset:41984
    s_waitcnt lgkmcnt(14)
    v_mfma_f32_16x16x32_bf16 v[56:59], v[124:127], a[88:91], v[56:59]
    ds_read_b64_tr_b16 v[92:93], v135 offset:40960
    buffer_load_dwordx4 a[44:47], v148, s[24:27], s34 offen offset:2304 sc1
    s_add_u32 s34, s34, 4096
    s_cmp_eq_u32 s34, 114688
    s_cselect_b32 s34, 0, s34
    v_mfma_f32_16x16x32_bf16 v[60:63], v[124:127], a[92:95], v[60:63]
    ds_read_b64_tr_b16 v[94:95], v135 offset:41984
    s_waitcnt vmcnt(28)
    s_waitcnt lgkmcnt(14)
    v_mfma_f32_16x16x32_bf16 v[0:3], v[64:67], a[96:99], v[0:3]
    ds_read_b64_tr_b16 v[96:97], v132 offset:49152
    v_mfma_f32_16x16x32_bf16 v[4:7], v[64:67], a[100:103], v[4:7]
    ds_read_b64_tr_b16 v[98:99], v132 offset:50176
    s_waitcnt lgkmcnt(14)
    v_mfma_f32_16x16x32_bf16 v[8:11], v[68:71], a[96:99], v[8:11]
    ds_read_b64_tr_b16 v[100:101], v133 offset:49152
    buffer_load_dwordx4 a[48:51], v148, s[24:27], s34 offen offset:0 sc1
    v_mfma_f32_16x16x32_bf16 v[12:15], v[68:71], a[100:103], v[12:15]
    ds_read_b64_tr_b16 v[102:103], v133 offset:50176
    s_waitcnt lgkmcnt(14)
    v_mfma_f32_16x16x32_bf16 v[16:19], v[72:75], a[96:99], v[16:19]
    ds_read_b64_tr_b16 v[104:105], v134 offset:49152
    v_mfma_f32_16x16x32_bf16 v[20:23], v[72:75], a[100:103], v[20:23]
    ds_read_b64_tr_b16 v[106:107], v134 offset:50176
    s_waitcnt lgkmcnt(14)
    v_mfma_f32_16x16x32_bf16 v[24:27], v[76:79], a[96:99], v[24:27]
    ds_read_b64_tr_b16 v[108:109], v135 offset:49152
    buffer_load_dwordx4 a[52:55], v148, s[24:27], s34 offen offset:256 sc1
    v_mfma_f32_16x16x32_bf16 v[28:31], v[76:79], a[100:103], v[28:31]
    ds_read_b64_tr_b16 v[110:111], v135 offset:50176
    s_waitcnt lgkmcnt(14)
    v_mfma_f32_16x16x32_bf16 v[0:3], v[80:83], a[104:107], v[0:3]
    ds_read_b64_tr_b16 v[112:113], v132 offset:57344
    v_mfma_f32_16x16x32_bf16 v[4:7], v[80:83], a[108:111], v[4:7]
    ds_read_b64_tr_b16 v[114:115], v132 offset:58368
    s_waitcnt lgkmcnt(14)
    v_mfma_f32_16x16x32_bf16 v[8:11], v[84:87], a[104:107], v[8:11]
    ds_read_b64_tr_b16 v[116:117], v133 offset:57344
    buffer_load_dwordx4 a[56:59], v148, s[24:27], s34 offen offset:2048 sc1
    v_mfma_f32_16x16x32_bf16 v[12:15], v[84:87], a[108:111], v[12:15]
    ds_read_b64_tr_b16 v[118:119], v133 offset:58368
    s_waitcnt lgkmcnt(14)
    v_mfma_f32_16x16x32_bf16 v[16:19], v[88:91], a[104:107], v[16:19]
    ds_read_b64_tr_b16 v[120:121], v134 offset:57344
    v_mfma_f32_16x16x32_bf16 v[20:23], v[88:91], a[108:111], v[20:23]
    ds_read_b64_tr_b16 v[122:123], v134 offset:58368
    s_waitcnt lgkmcnt(14)
    v_mfma_f32_16x16x32_bf16 v[24:27], v[92:95], a[104:107], v[24:27]
    ds_read_b64_tr_b16 v[124:125], v135 offset:57344
    buffer_load_dwordx4 a[60:63], v148, s[24:27], s34 offen offset:2304 sc1
    s_add_u32 s34, s34, 4096
    s_cmp_eq_u32 s34, 114688
    s_cselect_b32 s34, 0, s34
    v_mfma_f32_16x16x32_bf16 v[28:31], v[92:95], a[108:111], v[28:31]
    ds_read_b64_tr_b16 v[126:127], v135 offset:58368
    s_waitcnt vmcnt(24)
    s_waitcnt lgkmcnt(14)
    v_mfma_f32_16x16x32_bf16 v[0:3], v[96:99], a[112:115], v[0:3]
    ds_read_b64_tr_b16 v[64:65], v140 offset:0
    v_mfma_f32_16x16x32_bf16 v[4:7], v[96:99], a[116:119], v[4:7]
    ds_read_b64_tr_b16 v[66:67], v140 offset:1024
    s_waitcnt lgkmcnt(14)
    v_mfma_f32_16x16x32_bf16 v[8:11], v[100:103], a[112:115], v[8:11]
    ds_read_b64_tr_b16 v[68:69], v141 offset:0
    v_mfma_f32_16x16x32_bf16 v[12:15], v[100:103], a[116:119], v[12:15]
    ds_read_b64_tr_b16 v[70:71], v141 offset:1024
    s_waitcnt lgkmcnt(14)
    v_mfma_f32_16x16x32_bf16 v[16:19], v[104:107], a[112:115], v[16:19]
    ds_read_b64_tr_b16 v[72:73], v142 offset:0
    v_mfma_f32_16x16x32_bf16 v[20:23], v[104:107], a[116:119], v[20:23]
    ds_read_b64_tr_b16 v[74:75], v142 offset:1024
    s_waitcnt lgkmcnt(14)
    v_mfma_f32_16x16x32_bf16 v[24:27], v[108:111], a[112:115], v[24:27]
    ds_read_b64_tr_b16 v[76:77], v143 offset:0
    v_mfma_f32_16x16x32_bf16 v[28:31], v[108:111], a[116:119], v[28:31]
    ds_read_b64_tr_b16 v[78:79], v143 offset:1024
    s_waitcnt lgkmcnt(14)
    v_mfma_f32_16x16x32_bf16 v[0:3], v[112:115], a[120:123], v[0:3]
    ds_read_b64_tr_b16 v[80:81], v140 offset:8192
    v_mfma_f32_16x16x32_bf16 v[4:7], v[112:115], a[124:127], v[4:7]
    ds_read_b64_tr_b16 v[82:83], v140 offset:9216
    s_waitcnt lgkmcnt(14)
    v_mfma_f32_16x16x32_bf16 v[8:11], v[116:119], a[120:123], v[8:11]
    ds_read_b64_tr_b16 v[84:85], v141 offset:8192
    v_mfma_f32_16x16x32_bf16 v[12:15], v[116:119], a[124:127], v[12:15]
    ds_read_b64_tr_b16 v[86:87], v141 offset:9216
    s_waitcnt lgkmcnt(14)
    v_mfma_f32_16x16x32_bf16 v[16:19], v[120:123], a[120:123], v[16:19]
    ds_read_b64_tr_b16 v[88:89], v142 offset:8192
    v_mfma_f32_16x16x32_bf16 v[20:23], v[120:123], a[124:127], v[20:23]
    ds_read_b64_tr_b16 v[90:91], v142 offset:9216
    s_waitcnt lgkmcnt(14)
    v_mfma_f32_16x16x32_bf16 v[24:27], v[124:127], a[120:123], v[24:27]
    ds_read_b64_tr_b16 v[92:93], v143 offset:8192
    v_mfma_f32_16x16x32_bf16 v[28:31], v[124:127], a[124:127], v[28:31]
    ds_read_b64_tr_b16 v[94:95], v143 offset:9216
    s_waitcnt vmcnt(16)
    s_waitcnt lgkmcnt(14)
    v_mfma_f32_16x16x32_bf16 v[0:3], v[64:67], a[0:3], v[0:3]
    ds_read_b64_tr_b16 v[96:97], v140 offset:16384
    v_mfma_f32_16x16x32_bf16 v[4:7], v[64:67], a[4:7], v[4:7]
    ds_read_b64_tr_b16 v[98:99], v140 offset:17408
    s_waitcnt lgkmcnt(14)
    v_mfma_f32_16x16x32_bf16 v[8:11], v[68:71], a[0:3], v[8:11]
    ds_read_b64_tr_b16 v[100:101], v141 offset:16384
    v_mfma_f32_16x16x32_bf16 v[12:15], v[68:71], a[4:7], v[12:15]
    ds_read_b64_tr_b16 v[102:103], v141 offset:17408
    s_waitcnt lgkmcnt(14)
    v_mfma_f32_16x16x32_bf16 v[16:19], v[72:75], a[0:3], v[16:19]
    ds_read_b64_tr_b16 v[104:105], v142 offset:16384
    v_mfma_f32_16x16x32_bf16 v[20:23], v[72:75], a[4:7], v[20:23]
    ds_read_b64_tr_b16 v[106:107], v142 offset:17408
    s_waitcnt lgkmcnt(14)
    v_mfma_f32_16x16x32_bf16 v[24:27], v[76:79], a[0:3], v[24:27]
    ds_read_b64_tr_b16 v[108:109], v143 offset:16384
    v_mfma_f32_16x16x32_bf16 v[28:31], v[76:79], a[4:7], v[28:31]
    ds_read_b64_tr_b16 v[110:111], v143 offset:17408
    s_waitcnt lgkmcnt(14)
    v_mfma_f32_16x16x32_bf16 v[0:3], v[80:83], a[8:11], v[0:3]
    ds_read_b64_tr_b16 v[112:113], v140 offset:24576
    v_mfma_f32_16x16x32_bf16 v[4:7], v[80:83], a[12:15], v[4:7]
    ds_read_b64_tr_b16 v[114:115], v140 offset:25600
    s_waitcnt lgkmcnt(14)
    v_mfma_f32_16x16x32_bf16 v[8:11], v[84:87], a[8:11], v[8:11]
    ds_read_b64_tr_b16 v[116:117], v141 offset:24576
    v_mfma_f32_16x16x32_bf16 v[12:15], v[84:87], a[12:15], v[12:15]
    ds_read_b64_tr_b16 v[118:119], v141 offset:25600
    s_waitcnt lgkmcnt(14)
    v_mfma_f32_16x16x32_bf16 v[16:19], v[88:91], a[8:11], v[16:19]
    ds_read_b64_tr_b16 v[120:121], v142 offset:24576
    v_mfma_f32_16x16x32_bf16 v[20:23], v[88:91], a[12:15], v[20:23]
    ds_read_b64_tr_b16 v[122:123], v142 offset:25600
    s_waitcnt lgkmcnt(14)
    v_mfma_f32_16x16x32_bf16 v[24:27], v[92:95], a[8:11], v[24:27]
    ds_read_b64_tr_b16 v[124:125], v143 offset:24576
    v_mfma_f32_16x16x32_bf16 v[28:31], v[92:95], a[12:15], v[28:31]
    ds_read_b64_tr_b16 v[126:127], v143 offset:25600
    s_waitcnt vmcnt(8)
    s_waitcnt lgkmcnt(14)
    v_mfma_f32_16x16x32_bf16 v[0:3], v[96:99], a[16:19], v[0:3]
    ds_read_b64_tr_b16 v[64:65], v140 offset:32768
    v_mfma_f32_16x16x32_bf16 v[4:7], v[96:99], a[20:23], v[4:7]
    ds_read_b64_tr_b16 v[66:67], v140 offset:33792
    s_waitcnt lgkmcnt(14)
    v_mfma_f32_16x16x32_bf16 v[8:11], v[100:103], a[16:19], v[8:11]
    ds_read_b64_tr_b16 v[68:69], v141 offset:32768
    v_mfma_f32_16x16x32_bf16 v[12:15], v[100:103], a[20:23], v[12:15]
    ds_read_b64_tr_b16 v[70:71], v141 offset:33792
    s_waitcnt lgkmcnt(14)
    v_mfma_f32_16x16x32_bf16 v[16:19], v[104:107], a[16:19], v[16:19]
    ds_read_b64_tr_b16 v[72:73], v142 offset:32768
    v_mfma_f32_16x16x32_bf16 v[20:23], v[104:107], a[20:23], v[20:23]
    ds_read_b64_tr_b16 v[74:75], v142 offset:33792
    s_waitcnt lgkmcnt(14)
    v_mfma_f32_16x16x32_bf16 v[24:27], v[108:111], a[16:19], v[24:27]
    ds_read_b64_tr_b16 v[76:77], v143 offset:32768
    v_mfma_f32_16x16x32_bf16 v[28:31], v[108:111], a[20:23], v[28:31]
    ds_read_b64_tr_b16 v[78:79], v143 offset:33792
    s_waitcnt lgkmcnt(14)
    v_mfma_f32_16x16x32_bf16 v[0:3], v[112:115], a[24:27], v[0:3]
    ds_read_b64_tr_b16 v[80:81], v140 offset:40960
    v_mfma_f32_16x16x32_bf16 v[4:7], v[112:115], a[28:31], v[4:7]
    ds_read_b64_tr_b16 v[82:83], v140 offset:41984
    s_waitcnt lgkmcnt(14)
    v_mfma_f32_16x16x32_bf16 v[8:11], v[116:119], a[24:27], v[8:11]
    ds_read_b64_tr_b16 v[84:85], v141 offset:40960
    v_mfma_f32_16x16x32_bf16 v[12:15], v[116:119], a[28:31], v[12:15]
    ds_read_b64_tr_b16 v[86:87], v141 offset:41984
    s_waitcnt lgkmcnt(14)
    v_mfma_f32_16x16x32_bf16 v[16:19], v[120:123], a[24:27], v[16:19]
    ds_read_b64_tr_b16 v[88:89], v142 offset:40960
    v_mfma_f32_16x16x32_bf16 v[20:23], v[120:123], a[28:31], v[20:23]
    ds_read_b64_tr_b16 v[90:91], v142 offset:41984
    s_waitcnt lgkmcnt(14)
    v_mfma_f32_16x16x32_bf16 v[24:27], v[124:127], a[24:27], v[24:27]
    ds_read_b64_tr_b16 v[92:93], v143 offset:40960
    v_mfma_f32_16x16x32_bf16 v[28:31], v[124:127], a[28:31], v[28:31]
    ds_read_b64_tr_b16 v[94:95], v143 offset:41984
    s_waitcnt vmcnt(4)
    s_barrier
    s_waitcnt lgkmcnt(14)
    v_mfma_f32_16x16x32_bf16 v[0:3], v[64:67], a[32:35], v[0:3]
    ds_read_b64_tr_b16 v[96:97], v140 offset:49152
    v_lshlrev_b32 v150, 4, v251
    v_mfma_f32_16x16x32_bf16 v[4:7], v[64:67], a[36:39], v[4:7]
    ds_read_b64_tr_b16 v[98:99], v140 offset:50176
    s_waitcnt lgkmcnt(14)
    s_lshl_b32 s7, s37, 16
    s_lshl_b32 s8, s6, 8
    v_mfma_f32_16x16x32_bf16 v[8:11], v[68:71], a[32:35], v[8:11]
    ds_read_b64_tr_b16 v[100:101], v141 offset:49152
    s_add_u32 s7, s7, s8
    s_lshl_b32 s8, s4, 7
    v_mfma_f32_16x16x32_bf16 v[12:15], v[68:71], a[36:39], v[12:15]
    ds_read_b64_tr_b16 v[102:103], v141 offset:50176
    s_waitcnt lgkmcnt(14)
    s_xor_b32 s44, s42, 131072
    s_add_u32 s7, s7, s8
    v_mfma_f32_16x16x32_bf16 v[16:19], v[72:75], a[32:35], v[16:19]
    ds_read_b64_tr_b16 v[104:105], v142 offset:49152
    s_add_u32 s45, s44, 4096
    v_mfma_f32_16x16x32_bf16 v[20:23], v[72:75], a[36:39], v[20:23]
    ds_read_b64_tr_b16 v[106:107], v142 offset:50176
    s_waitcnt lgkmcnt(14)
    s_mov_b32 s12, s60
    s_and_b32 s13, s61, 0xffff
    v_mfma_f32_16x16x32_bf16 v[24:27], v[76:79], a[32:35], v[24:27]
    ds_read_b64_tr_b16 v[108:109], v143 offset:49152
    s_mov_b32 s14, 4194304
    s_mov_b32 s15, 0x00020000
    v_mfma_f32_16x16x32_bf16 v[28:31], v[76:79], a[36:39], v[28:31]
    ds_read_b64_tr_b16 v[110:111], v143 offset:50176
    s_waitcnt lgkmcnt(14)
    s_mov_b32 s39, 32768
    v_mfma_f32_16x16x32_bf16 v[0:3], v[80:83], a[40:43], v[0:3]
    ds_read_b64_tr_b16 v[112:113], v140 offset:57344
    v_mfma_f32_16x16x32_bf16 v[4:7], v[80:83], a[44:47], v[4:7]
    ds_read_b64_tr_b16 v[114:115], v140 offset:58368
    s_waitcnt lgkmcnt(14)
    v_mfma_f32_16x16x32_bf16 v[8:11], v[84:87], a[40:43], v[8:11]
    ds_read_b64_tr_b16 v[116:117], v141 offset:57344
    v_and_b32 v154, 15, v251
    v_lshlrev_b32 v154, 11, v154
    v_mfma_f32_16x16x32_bf16 v[12:15], v[84:87], a[44:47], v[12:15]
    ds_read_b64_tr_b16 v[118:119], v141 offset:58368
    s_waitcnt lgkmcnt(14)
    v_bfe_u32 v155, v251, 4, 1
    v_lshl_add_u32 v154, v155, 5, v154
    v_mfma_f32_16x16x32_bf16 v[16:19], v[88:91], a[40:43], v[16:19]
    ds_read_b64_tr_b16 v[120:121], v142 offset:57344
    v_lshrrev_b32 v155, 5, v251
    v_lshl_add_u32 v154, v155, 4, v154
    v_mfma_f32_16x16x32_bf16 v[20:23], v[88:91], a[44:47], v[20:23]
    ds_read_b64_tr_b16 v[122:123], v142 offset:58368
    s_waitcnt lgkmcnt(14)
    v_add_u32 v149, s7, v154
    v_mfma_f32_16x16x32_bf16 v[24:27], v[92:95], a[40:43], v[24:27]
    ds_read_b64_tr_b16 v[124:125], v143 offset:57344
    v_mfma_f32_16x16x32_bf16 v[28:31], v[92:95], a[44:47], v[28:31]
    ds_read_b64_tr_b16 v[126:127], v143 offset:58368
    s_waitcnt vmcnt(0)
    s_waitcnt lgkmcnt(14)
    v_mfma_f32_16x16x32_bf16 v[0:3], v[96:99], a[48:51], v[0:3]
    ds_read_b64_tr_b16 v[64:65], v136 offset:32768
    s_lshr_b32 s46, s36, 0
    v_mfma_f32_16x16x32_bf16 v[4:7], v[96:99], a[52:55], v[4:7]
    ds_read_b64_tr_b16 v[66:67], v136 offset:33792
    s_waitcnt lgkmcnt(14)
    v_mfma_f32_16x16x32_bf16 v[8:11], v[100:103], a[48:51], v[8:11]
    ds_read_b64_tr_b16 v[68:69], v137 offset:32768
    s_lshr_b32 s47, s36, 8
    v_mfma_f32_16x16x32_bf16 v[12:15], v[100:103], a[52:55], v[12:15]
    ds_read_b64_tr_b16 v[70:71], v137 offset:33792
    s_waitcnt lgkmcnt(14)
    v_mfma_f32_16x16x32_bf16 v[16:19], v[104:107], a[48:51], v[16:19]
    ds_read_b64_tr_b16 v[72:73], v138 offset:32768
    s_lshr_b32 s48, s36, 16
    v_mfma_f32_16x16x32_bf16 v[20:23], v[104:107], a[52:55], v[20:23]
    ds_read_b64_tr_b16 v[74:75], v138 offset:33792
    s_waitcnt lgkmcnt(14)
    v_mfma_f32_16x16x32_bf16 v[24:27], v[108:111], a[48:51], v[24:27]
    ds_read_b64_tr_b16 v[76:77], v139 offset:32768
    s_lshr_b32 s49, s36, 24
    v_mfma_f32_16x16x32_bf16 v[28:31], v[108:111], a[52:55], v[28:31]
    ds_read_b64_tr_b16 v[78:79], v139 offset:33792
    s_waitcnt lgkmcnt(14)
    v_mfma_f32_16x16x32_bf16 v[0:3], v[112:115], a[56:59], v[0:3]
    ds_read_b64_tr_b16 v[80:81], v136 offset:40960
    s_mov_b32 s50, 117835008
    v_mfma_f32_16x16x32_bf16 v[4:7], v[112:115], a[60:63], v[4:7]
    ds_read_b64_tr_b16 v[82:83], v136 offset:41984
    s_waitcnt lgkmcnt(14)
    v_mfma_f32_16x16x32_bf16 v[8:11], v[116:119], a[56:59], v[8:11]
    ds_read_b64_tr_b16 v[84:85], v137 offset:40960
    s_mov_b32 s51, 117835009
    v_mfma_f32_16x16x32_bf16 v[12:15], v[116:119], a[60:63], v[12:15]
    ds_read_b64_tr_b16 v[86:87], v137 offset:41984
    s_waitcnt lgkmcnt(14)
    v_mfma_f32_16x16x32_bf16 v[16:19], v[120:123], a[56:59], v[16:19]
    ds_read_b64_tr_b16 v[88:89], v138 offset:40960
    s_mov_b32 s52, 117835010
    v_mfma_f32_16x16x32_bf16 v[20:23], v[120:123], a[60:63], v[20:23]
    ds_read_b64_tr_b16 v[90:91], v138 offset:41984
    s_waitcnt lgkmcnt(14)
    v_mfma_f32_16x16x32_bf16 v[24:27], v[124:127], a[56:59], v[24:27]
    ds_read_b64_tr_b16 v[92:93], v139 offset:40960
    s_mov_b32 s53, 117835011
    v_mfma_f32_16x16x32_bf16 v[28:31], v[124:127], a[60:63], v[28:31]
    ds_read_b64_tr_b16 v[94:95], v139 offset:41984
    s_mov_b32 s54, 0xffffff00
    s_waitcnt lgkmcnt(14)
    v_mfma_f32_16x16x32_bf16 v[32:35], v[64:67], a[96:99], v[32:35]
    ds_read_b64_tr_b16 v[96:97], v136 offset:49152
    v_mfma_f32_16x16x32_bf16 v[36:39], v[64:67], a[100:103], v[36:39]
    ds_read_b64_tr_b16 v[98:99], v136 offset:50176
    s_waitcnt lgkmcnt(14)
    v_mfma_f32_16x16x32_bf16 v[40:43], v[68:71], a[96:99], v[40:43]
    ds_read_b64_tr_b16 v[100:101], v137 offset:49152
    v_mfma_f32_16x16x32_bf16 v[44:47], v[68:71], a[100:103], v[44:47]
    ds_read_b64_tr_b16 v[102:103], v137 offset:50176
    s_waitcnt lgkmcnt(14)
    v_perm_b32 v0, v0, v151, s50
    v_perm_b32 v1, v1, v151, s51
    v_perm_b32 v2, v2, v151, s52
    v_perm_b32 v3, v3, v151, s53
    v_mfma_f32_16x16x32_bf16 v[48:51], v[72:75], a[96:99], v[48:51]
    ds_read_b64_tr_b16 v[104:105], v138 offset:49152
    buffer_store_dwordx4 v[0:3], v150, s[28:31], s42 offen offset:0 sc1
    v_perm_b32 v4, v4, v151, s50
    v_perm_b32 v5, v5, v151, s51
    v_perm_b32 v6, v6, v151, s52
    v_perm_b32 v7, v7, v151, s53
    v_mfma_f32_16x16x32_bf16 v[52:55], v[72:75], a[100:103], v[52:55]
    ds_read_b64_tr_b16 v[106:107], v138 offset:50176
    s_waitcnt lgkmcnt(14)
    buffer_store_dwordx4 v[4:7], v150, s[28:31], s42 offen offset:1024 sc1
    v_perm_b32 v8, v8, v151, s50
    v_perm_b32 v9, v9, v151, s51
    v_perm_b32 v10, v10, v151, s52
    v_perm_b32 v11, v11, v151, s53
    v_mfma_f32_16x16x32_bf16 v[56:59], v[76:79], a[96:99], v[56:59]
    ds_read_b64_tr_b16 v[108:109], v139 offset:49152
    buffer_store_dwordx4 v[8:11], v150, s[28:31], s42 offen offset:2048 sc1
    v_perm_b32 v12, v12, v151, s50
    v_perm_b32 v13, v13, v151, s51
    v_perm_b32 v14, v14, v151, s52
    v_perm_b32 v15, v15, v151, s53
    v_mfma_f32_16x16x32_bf16 v[60:63], v[76:79], a[100:103], v[60:63]
    ds_read_b64_tr_b16 v[110:111], v139 offset:50176
    s_waitcnt lgkmcnt(14)
    buffer_store_dwordx4 v[12:15], v150, s[28:31], s42 offen offset:3072 sc1
    v_perm_b32 v16, v16, v151, s50
    v_perm_b32 v17, v17, v151, s51
    v_perm_b32 v18, v18, v151, s52
    v_perm_b32 v19, v19, v151, s53
    v_mfma_f32_16x16x32_bf16 v[32:35], v[80:83], a[104:107], v[32:35]
    ds_read_b64_tr_b16 v[112:113], v136 offset:57344
    buffer_store_dwordx4 v[16:19], v150, s[28:31], s43 offen offset:0 sc1
    v_perm_b32 v20, v20, v151, s50
    v_perm_b32 v21, v21, v151, s51
    v_perm_b32 v22, v22, v151, s52
    v_perm_b32 v23, v23, v151, s53
    v_mfma_f32_16x16x32_bf16 v[36:39], v[80:83], a[108:111], v[36:39]
    ds_read_b64_tr_b16 v[114:115], v136 offset:58368
    s_waitcnt lgkmcnt(14)
    buffer_store_dwordx4 v[20:23], v150, s[28:31], s43 offen offset:1024 sc1
    v_perm_b32 v24, v24, v151, s50
    v_perm_b32 v25, v25, v151, s51
    v_perm_b32 v26, v26, v151, s52
    v_perm_b32 v27, v27, v151, s53
    v_mfma_f32_16x16x32_bf16 v[40:43], v[84:87], a[104:107], v[40:43]
    ds_read_b64_tr_b16 v[116:117], v137 offset:57344
    buffer_store_dwordx4 v[24:27], v150, s[28:31], s43 offen offset:2048 sc1
    v_perm_b32 v28, v28, v151, s50
    v_perm_b32 v29, v29, v151, s51
    v_perm_b32 v30, v30, v151, s52
    v_perm_b32 v31, v31, v151, s53
    v_mfma_f32_16x16x32_bf16 v[44:47], v[84:87], a[108:111], v[44:47]
    ds_read_b64_tr_b16 v[118:119], v137 offset:58368
    s_waitcnt lgkmcnt(14)
    buffer_store_dwordx4 v[28:31], v150, s[28:31], s43 offen offset:3072 sc1
    v_mfma_f32_16x16x32_bf16 v[48:51], v[88:91], a[104:107], v[48:51]
    ds_read_b64_tr_b16 v[120:121], v138 offset:57344
    v_mfma_f32_16x16x32_bf16 v[52:55], v[88:91], a[108:111], v[52:55]
    ds_read_b64_tr_b16 v[122:123], v138 offset:58368
    s_waitcnt lgkmcnt(14)
    v_mfma_f32_16x16x32_bf16 v[56:59], v[92:95], a[104:107], v[56:59]
    ds_read_b64_tr_b16 v[124:125], v139 offset:57344
    v_mfma_f32_16x16x32_bf16 v[60:63], v[92:95], a[108:111], v[60:63]
    ds_read_b64_tr_b16 v[126:127], v139 offset:58368
    s_waitcnt lgkmcnt(14)
    v_mfma_f32_16x16x32_bf16 v[32:35], v[96:99], a[112:115], v[32:35]
    ds_read_b64_tr_b16 v[64:65], v144 offset:0
    v_mfma_f32_16x16x32_bf16 v[36:39], v[96:99], a[116:119], v[36:39]
    ds_read_b64_tr_b16 v[66:67], v144 offset:1024
    s_waitcnt lgkmcnt(14)
    v_mfma_f32_16x16x32_bf16 v[40:43], v[100:103], a[112:115], v[40:43]
    ds_read_b64_tr_b16 v[68:69], v145 offset:0
    v_mfma_f32_16x16x32_bf16 v[44:47], v[100:103], a[116:119], v[44:47]
    ds_read_b64_tr_b16 v[70:71], v145 offset:1024
    s_waitcnt lgkmcnt(14)
    v_mfma_f32_16x16x32_bf16 v[48:51], v[104:107], a[112:115], v[48:51]
    ds_read_b64_tr_b16 v[72:73], v146 offset:0
    v_mfma_f32_16x16x32_bf16 v[52:55], v[104:107], a[116:119], v[52:55]
    ds_read_b64_tr_b16 v[74:75], v146 offset:1024
    s_waitcnt lgkmcnt(14)
    v_mfma_f32_16x16x32_bf16 v[56:59], v[108:111], a[112:115], v[56:59]
    ds_read_b64_tr_b16 v[76:77], v147 offset:0
    v_mfma_f32_16x16x32_bf16 v[60:63], v[108:111], a[116:119], v[60:63]
    ds_read_b64_tr_b16 v[78:79], v147 offset:1024
    s_waitcnt lgkmcnt(14)
    v_mfma_f32_16x16x32_bf16 v[32:35], v[112:115], a[120:123], v[32:35]
    ds_read_b64_tr_b16 v[80:81], v144 offset:8192
    v_mfma_f32_16x16x32_bf16 v[36:39], v[112:115], a[124:127], v[36:39]
    ds_read_b64_tr_b16 v[82:83], v144 offset:9216
    s_waitcnt lgkmcnt(14)
    v_mfma_f32_16x16x32_bf16 v[40:43], v[116:119], a[120:123], v[40:43]
    ds_read_b64_tr_b16 v[84:85], v145 offset:8192
    v_mfma_f32_16x16x32_bf16 v[44:47], v[116:119], a[124:127], v[44:47]
    ds_read_b64_tr_b16 v[86:87], v145 offset:9216
    s_waitcnt lgkmcnt(14)
    v_mfma_f32_16x16x32_bf16 v[48:51], v[120:123], a[120:123], v[48:51]
    ds_read_b64_tr_b16 v[88:89], v146 offset:8192
    v_mfma_f32_16x16x32_bf16 v[52:55], v[120:123], a[124:127], v[52:55]
    ds_read_b64_tr_b16 v[90:91], v146 offset:9216
    s_waitcnt lgkmcnt(14)
    v_mfma_f32_16x16x32_bf16 v[56:59], v[124:127], a[120:123], v[56:59]
    ds_read_b64_tr_b16 v[92:93], v147 offset:8192
    v_mfma_f32_16x16x32_bf16 v[60:63], v[124:127], a[124:127], v[60:63]
    ds_read_b64_tr_b16 v[94:95], v147 offset:9216
    s_waitcnt lgkmcnt(14)
    v_mfma_f32_16x16x32_bf16 v[32:35], v[64:67], a[0:3], v[32:35]
    ds_read_b64_tr_b16 v[96:97], v144 offset:16384
    v_mfma_f32_16x16x32_bf16 v[36:39], v[64:67], a[4:7], v[36:39]
    ds_read_b64_tr_b16 v[98:99], v144 offset:17408
    s_waitcnt lgkmcnt(14)
    v_mfma_f32_16x16x32_bf16 v[40:43], v[68:71], a[0:3], v[40:43]
    ds_read_b64_tr_b16 v[100:101], v145 offset:16384
    v_mfma_f32_16x16x32_bf16 v[44:47], v[68:71], a[4:7], v[44:47]
    ds_read_b64_tr_b16 v[102:103], v145 offset:17408
    s_waitcnt lgkmcnt(14)
    v_mfma_f32_16x16x32_bf16 v[48:51], v[72:75], a[0:3], v[48:51]
    ds_read_b64_tr_b16 v[104:105], v146 offset:16384
    v_mfma_f32_16x16x32_bf16 v[52:55], v[72:75], a[4:7], v[52:55]
    ds_read_b64_tr_b16 v[106:107], v146 offset:17408
    s_waitcnt lgkmcnt(14)
    v_mfma_f32_16x16x32_bf16 v[56:59], v[76:79], a[0:3], v[56:59]
    ds_read_b64_tr_b16 v[108:109], v147 offset:16384
    v_mfma_f32_16x16x32_bf16 v[60:63], v[76:79], a[4:7], v[60:63]
    ds_read_b64_tr_b16 v[110:111], v147 offset:17408
    s_waitcnt lgkmcnt(14)
    v_mfma_f32_16x16x32_bf16 v[32:35], v[80:83], a[8:11], v[32:35]
    ds_read_b64_tr_b16 v[112:113], v144 offset:24576
    v_mfma_f32_16x16x32_bf16 v[36:39], v[80:83], a[12:15], v[36:39]
    ds_read_b64_tr_b16 v[114:115], v144 offset:25600
    s_waitcnt lgkmcnt(14)
    v_mfma_f32_16x16x32_bf16 v[40:43], v[84:87], a[8:11], v[40:43]
    ds_read_b64_tr_b16 v[116:117], v145 offset:24576
    v_mfma_f32_16x16x32_bf16 v[44:47], v[84:87], a[12:15], v[44:47]
    ds_read_b64_tr_b16 v[118:119], v145 offset:25600
    s_waitcnt lgkmcnt(14)
    v_mfma_f32_16x16x32_bf16 v[48:51], v[88:91], a[8:11], v[48:51]
    ds_read_b64_tr_b16 v[120:121], v146 offset:24576
    v_mfma_f32_16x16x32_bf16 v[52:55], v[88:91], a[12:15], v[52:55]
    ds_read_b64_tr_b16 v[122:123], v146 offset:25600
    s_waitcnt lgkmcnt(14)
    v_mfma_f32_16x16x32_bf16 v[56:59], v[92:95], a[8:11], v[56:59]
    ds_read_b64_tr_b16 v[124:125], v147 offset:24576
    v_mfma_f32_16x16x32_bf16 v[60:63], v[92:95], a[12:15], v[60:63]
    ds_read_b64_tr_b16 v[126:127], v147 offset:25600
    s_waitcnt lgkmcnt(14)
    v_mfma_f32_16x16x32_bf16 v[32:35], v[96:99], a[16:19], v[32:35]
    ds_read_b64_tr_b16 v[64:65], v144 offset:32768
    v_mfma_f32_16x16x32_bf16 v[36:39], v[96:99], a[20:23], v[36:39]
    ds_read_b64_tr_b16 v[66:67], v144 offset:33792
    s_waitcnt lgkmcnt(14)
    v_mfma_f32_16x16x32_bf16 v[40:43], v[100:103], a[16:19], v[40:43]
    ds_read_b64_tr_b16 v[68:69], v145 offset:32768
    v_mfma_f32_16x16x32_bf16 v[44:47], v[100:103], a[20:23], v[44:47]
    ds_read_b64_tr_b16 v[70:71], v145 offset:33792
    s_waitcnt lgkmcnt(14)
    v_mfma_f32_16x16x32_bf16 v[48:51], v[104:107], a[16:19], v[48:51]
    ds_read_b64_tr_b16 v[72:73], v146 offset:32768
    v_mfma_f32_16x16x32_bf16 v[52:55], v[104:107], a[20:23], v[52:55]
    ds_read_b64_tr_b16 v[74:75], v146 offset:33792
    s_waitcnt lgkmcnt(14)
    v_mfma_f32_16x16x32_bf16 v[56:59], v[108:111], a[16:19], v[56:59]
    ds_read_b64_tr_b16 v[76:77], v147 offset:32768
    v_mfma_f32_16x16x32_bf16 v[60:63], v[108:111], a[20:23], v[60:63]
    ds_read_b64_tr_b16 v[78:79], v147 offset:33792
    s_waitcnt lgkmcnt(14)
    v_mfma_f32_16x16x32_bf16 v[32:35], v[112:115], a[24:27], v[32:35]
    ds_read_b64_tr_b16 v[80:81], v144 offset:40960
    v_mfma_f32_16x16x32_bf16 v[36:39], v[112:115], a[28:31], v[36:39]
    ds_read_b64_tr_b16 v[82:83], v144 offset:41984
    s_waitcnt lgkmcnt(14)
    v_mfma_f32_16x16x32_bf16 v[40:43], v[116:119], a[24:27], v[40:43]
    ds_read_b64_tr_b16 v[84:85], v145 offset:40960
    v_mfma_f32_16x16x32_bf16 v[44:47], v[116:119], a[28:31], v[44:47]
    ds_read_b64_tr_b16 v[86:87], v145 offset:41984
    s_waitcnt lgkmcnt(14)
    v_mfma_f32_16x16x32_bf16 v[48:51], v[120:123], a[24:27], v[48:51]
    ds_read_b64_tr_b16 v[88:89], v146 offset:40960
    v_mfma_f32_16x16x32_bf16 v[52:55], v[120:123], a[28:31], v[52:55]
    ds_read_b64_tr_b16 v[90:91], v146 offset:41984
    s_waitcnt lgkmcnt(14)
    v_mfma_f32_16x16x32_bf16 v[56:59], v[124:127], a[24:27], v[56:59]
    ds_read_b64_tr_b16 v[92:93], v147 offset:40960
    v_mfma_f32_16x16x32_bf16 v[60:63], v[124:127], a[28:31], v[60:63]
    ds_read_b64_tr_b16 v[94:95], v147 offset:41984
    s_waitcnt lgkmcnt(14)
    v_mfma_f32_16x16x32_bf16 v[32:35], v[64:67], a[32:35], v[32:35]
    ds_read_b64_tr_b16 v[96:97], v144 offset:49152
    v_mfma_f32_16x16x32_bf16 v[36:39], v[64:67], a[36:39], v[36:39]
    ds_read_b64_tr_b16 v[98:99], v144 offset:50176
    s_waitcnt lgkmcnt(14)
    v_mfma_f32_16x16x32_bf16 v[40:43], v[68:71], a[32:35], v[40:43]
    ds_read_b64_tr_b16 v[100:101], v145 offset:49152
    v_mfma_f32_16x16x32_bf16 v[44:47], v[68:71], a[36:39], v[44:47]
    ds_read_b64_tr_b16 v[102:103], v145 offset:50176
    s_waitcnt lgkmcnt(14)
    v_mfma_f32_16x16x32_bf16 v[48:51], v[72:75], a[32:35], v[48:51]
    ds_read_b64_tr_b16 v[104:105], v146 offset:49152
    v_mfma_f32_16x16x32_bf16 v[52:55], v[72:75], a[36:39], v[52:55]
    ds_read_b64_tr_b16 v[106:107], v146 offset:50176
    s_waitcnt lgkmcnt(14)
    v_mfma_f32_16x16x32_bf16 v[56:59], v[76:79], a[32:35], v[56:59]
    ds_read_b64_tr_b16 v[108:109], v147 offset:49152
    v_mfma_f32_16x16x32_bf16 v[60:63], v[76:79], a[36:39], v[60:63]
    ds_read_b64_tr_b16 v[110:111], v147 offset:50176
    s_waitcnt lgkmcnt(14)
    v_mfma_f32_16x16x32_bf16 v[32:35], v[80:83], a[40:43], v[32:35]
    ds_read_b64_tr_b16 v[112:113], v144 offset:57344
    v_mfma_f32_16x16x32_bf16 v[36:39], v[80:83], a[44:47], v[36:39]
    ds_read_b64_tr_b16 v[114:115], v144 offset:58368
    s_waitcnt lgkmcnt(14)
    v_mfma_f32_16x16x32_bf16 v[40:43], v[84:87], a[40:43], v[40:43]
    ds_read_b64_tr_b16 v[116:117], v145 offset:57344
    v_mfma_f32_16x16x32_bf16 v[44:47], v[84:87], a[44:47], v[44:47]
    ds_read_b64_tr_b16 v[118:119], v145 offset:58368
    s_waitcnt lgkmcnt(14)
    v_mfma_f32_16x16x32_bf16 v[48:51], v[88:91], a[40:43], v[48:51]
    ds_read_b64_tr_b16 v[120:121], v146 offset:57344
    v_mfma_f32_16x16x32_bf16 v[52:55], v[88:91], a[44:47], v[52:55]
    ds_read_b64_tr_b16 v[122:123], v146 offset:58368
    s_waitcnt lgkmcnt(14)
    v_mfma_f32_16x16x32_bf16 v[56:59], v[92:95], a[40:43], v[56:59]
    ds_read_b64_tr_b16 v[124:125], v147 offset:57344
    v_mfma_f32_16x16x32_bf16 v[60:63], v[92:95], a[44:47], v[60:63]
    ds_read_b64_tr_b16 v[126:127], v147 offset:58368
    s_waitcnt lgkmcnt(14)
    v_mfma_f32_16x16x32_bf16 v[32:35], v[96:99], a[48:51], v[32:35]
    v_mfma_f32_16x16x32_bf16 v[36:39], v[96:99], a[52:55], v[36:39]
    s_waitcnt lgkmcnt(12)
    s_mov_b32 exec_lo, 0
    s_brev_b32 exec_hi, 1
    buffer_load_dwordx4 v[224:227], v150, s[28:31], s45 offen offset:3072 sc1
    s_mov_b64 exec, -1
    v_mfma_f32_16x16x32_bf16 v[40:43], v[100:103], a[48:51], v[40:43]
    v_mfma_f32_16x16x32_bf16 v[44:47], v[100:103], a[52:55], v[44:47]
    s_waitcnt lgkmcnt(10)
    v_mfma_f32_16x16x32_bf16 v[48:51], v[104:107], a[48:51], v[48:51]
    v_mfma_f32_16x16x32_bf16 v[52:55], v[104:107], a[52:55], v[52:55]
    s_waitcnt lgkmcnt(8)
    v_mfma_f32_16x16x32_bf16 v[56:59], v[108:111], a[48:51], v[56:59]
    v_mfma_f32_16x16x32_bf16 v[60:63], v[108:111], a[52:55], v[60:63]
    s_waitcnt lgkmcnt(6)
    v_mfma_f32_16x16x32_bf16 v[32:35], v[112:115], a[56:59], v[32:35]
    v_mfma_f32_16x16x32_bf16 v[36:39], v[112:115], a[60:63], v[36:39]
    s_waitcnt lgkmcnt(4)
    v_mfma_f32_16x16x32_bf16 v[40:43], v[116:119], a[56:59], v[40:43]
    v_mfma_f32_16x16x32_bf16 v[44:47], v[116:119], a[60:63], v[44:47]
    s_waitcnt lgkmcnt(2)
    v_mfma_f32_16x16x32_bf16 v[48:51], v[120:123], a[56:59], v[48:51]
    v_mfma_f32_16x16x32_bf16 v[52:55], v[120:123], a[60:63], v[52:55]
    s_waitcnt lgkmcnt(0)
    v_mfma_f32_16x16x32_bf16 v[56:59], v[124:127], a[56:59], v[56:59]
    v_mfma_f32_16x16x32_bf16 v[60:63], v[124:127], a[60:63], v[60:63]
    s_mov_b32 exec_lo, 0
    s_brev_b32 exec_hi, 1
    s_branch L2_k0
    s_waitcnt vmcnt(6)
L2_c0:
    v_xor_b32 v152, s46, v160
    v_xor_b32 v153, s46, v164
    v_bitop3_b32 v152, v161, s47, v152 bitop3:0xbe
    v_bitop3_b32 v153, v165, s47, v153 bitop3:0xbe
    v_bitop3_b32 v152, v162, s48, v152 bitop3:0xbe
    v_bitop3_b32 v153, v166, s48, v153 bitop3:0xbe
    v_bitop3_b32 v152, v163, s49, v152 bitop3:0xbe
    v_bitop3_b32 v153, v167, s49, v153 bitop3:0xbe
    v_or_b32 v152, v152, v153
    v_and_b32 v152, 0xff, v152
    v_cmp_ne_u32 vcc, 0, v152
    v_and_b32 v160, s54, v160
    v_and_b32 v161, s54, v161
    v_and_b32 v162, s54, v162
    v_and_b32 v163, s54, v163
    v_and_b32 v164, s54, v164
    v_and_b32 v165, s54, v165
    v_and_b32 v166, s54, v166
    v_and_b32 v167, s54, v167
    s_cbranch_vccnz L2_r0
L2_o0:
    v_pk_add_f32 v[192:193], v[32:33], v[160:161]
    v_pk_add_f32 v[194:195], v[34:35], v[162:163]
    v_pk_add_f32 v[196:197], v[36:37], v[164:165]
    v_pk_add_f32 v[198:199], v[38:39], v[166:167]
    v_cvt_pk_bf16_f32 v96, v192, v193
    v_cvt_pk_bf16_f32 v97, v194, v195
    v_cvt_pk_bf16_f32 v100, v196, v197
    v_cvt_pk_bf16_f32 v101, v198, v199
    s_waitcnt vmcnt(4)
L2_c1:
    v_xor_b32 v152, s46, v168
    v_xor_b32 v153, s46, v172
    v_bitop3_b32 v152, v169, s47, v152 bitop3:0xbe
    v_bitop3_b32 v153, v173, s47, v153 bitop3:0xbe
    v_bitop3_b32 v152, v170, s48, v152 bitop3:0xbe
    v_bitop3_b32 v153, v174, s48, v153 bitop3:0xbe
    v_bitop3_b32 v152, v171, s49, v152 bitop3:0xbe
    v_bitop3_b32 v153, v175, s49, v153 bitop3:0xbe
    v_or_b32 v152, v152, v153
    v_and_b32 v152, 0xff, v152
    v_cmp_ne_u32 vcc, 0, v152
    v_and_b32 v168, s54, v168
    v_and_b32 v169, s54, v169
    v_and_b32 v170, s54, v170
    v_and_b32 v171, s54, v171
    v_and_b32 v172, s54, v172
    v_and_b32 v173, s54, v173
    v_and_b32 v174, s54, v174
    v_and_b32 v175, s54, v175
    s_cbranch_vccnz L2_r1
L2_o1:
    v_pk_add_f32 v[200:201], v[40:41], v[168:169]
    v_pk_add_f32 v[202:203], v[42:43], v[170:171]
    v_pk_add_f32 v[204:205], v[44:45], v[172:173]
    v_pk_add_f32 v[206:207], v[46:47], v[174:175]
    v_cvt_pk_bf16_f32 v98, v200, v201
    v_cvt_pk_bf16_f32 v99, v202, v203
    v_cvt_pk_bf16_f32 v102, v204, v205
    v_cvt_pk_bf16_f32 v103, v206, v207
    s_waitcnt vmcnt(2)
L2_c2:
    v_xor_b32 v152, s46, v176
    v_xor_b32 v153, s46, v180
    v_bitop3_b32 v152, v177, s47, v152 bitop3:0xbe
    v_bitop3_b32 v153, v181, s47, v153 bitop3:0xbe
    v_bitop3_b32 v152, v178, s48, v152 bitop3:0xbe
    v_bitop3_b32 v153, v182, s48, v153 bitop3:0xbe
    v_bitop3_b32 v152, v179, s49, v152 bitop3:0xbe
    v_bitop3_b32 v153, v183, s49, v153 bitop3:0xbe
    v_or_b32 v152, v152, v153
    v_and_b32 v152, 0xff, v152
    v_cmp_ne_u32 vcc, 0, v152
    v_and_b32 v176, s54, v176
    v_and_b32 v177, s54, v177
    v_and_b32 v178, s54, v178
    v_and_b32 v179, s54, v179
    v_and_b32 v180, s54, v180
    v_and_b32 v181, s54, v181
    v_and_b32 v182, s54, v182
    v_and_b32 v183, s54, v183
    s_cbranch_vccnz L2_r2
L2_o2:
    v_pk_add_f32 v[208:209], v[48:49], v[176:177]
    v_pk_add_f32 v[210:211], v[50:51], v[178:179]
    v_pk_add_f32 v[212:213], v[52:53], v[180:181]
    v_pk_add_f32 v[214:215], v[54:55], v[182:183]
    v_cvt_pk_bf16_f32 v104, v208, v209
    v_cvt_pk_bf16_f32 v105, v210, v211
    v_cvt_pk_bf16_f32 v108, v212, v213
    v_cvt_pk_bf16_f32 v109, v214, v215
    v_permlane16_swap_b32 v96, v98
    v_permlane16_swap_b32 v97, v99
    v_permlane16_swap_b32 v100, v102
    v_permlane16_swap_b32 v101, v103
    s_waitcnt vmcnt(0)
L2_c3:
    v_xor_b32 v152, s46, v184
    v_xor_b32 v153, s46, v188
    v_bitop3_b32 v152, v185, s47, v152 bitop3:0xbe
    v_bitop3_b32 v153, v189, s47, v153 bitop3:0xbe
    v_bitop3_b32 v152, v186, s48, v152 bitop3:0xbe
    v_bitop3_b32 v153, v190, s48, v153 bitop3:0xbe
    v_bitop3_b32 v152, v187, s49, v152 bitop3:0xbe
    v_bitop3_b32 v153, v191, s49, v153 bitop3:0xbe
    v_or_b32 v152, v152, v153
    v_and_b32 v152, 0xff, v152
    v_cmp_ne_u32 vcc, 0, v152
    v_and_b32 v184, s54, v184
    v_and_b32 v185, s54, v185
    v_and_b32 v186, s54, v186
    v_and_b32 v187, s54, v187
    v_and_b32 v188, s54, v188
    v_and_b32 v189, s54, v189
    v_and_b32 v190, s54, v190
    v_and_b32 v191, s54, v191
    s_cbranch_vccnz L2_r3
L2_o3:
    v_pk_add_f32 v[216:217], v[56:57], v[184:185]
    v_pk_add_f32 v[218:219], v[58:59], v[186:187]
    v_pk_add_f32 v[220:221], v[60:61], v[188:189]
    v_pk_add_f32 v[222:223], v[62:63], v[190:191]
    v_cvt_pk_bf16_f32 v106, v216, v217
    v_cvt_pk_bf16_f32 v107, v218, v219
    v_cvt_pk_bf16_f32 v110, v220, v221
    v_cvt_pk_bf16_f32 v111, v222, v223
    buffer_store_dwordx4 v[96:99], v149, s[12:15], 0 offen
    buffer_store_dwordx4 v[100:103], v149, s[12:15], s39 offen
    v_permlane16_swap_b32 v104, v106
    v_permlane16_swap_b32 v105, v107
    buffer_store_dwordx4 v[104:107], v149, s[12:15], 0 offen offset:64
    v_permlane16_swap_b32 v108, v110
    v_permlane16_swap_b32 v109, v111
    buffer_store_dwordx4 v[108:111], v149, s[12:15], s39 offen offset:64
    s_branch L2_fin
L2_w3:
    buffer_load_dword v238, v237, s[28:31], 0 offen sc1
    s_waitcnt vmcnt(0)
    v_cmp_eq_u32 vcc, s36, v238
    s_nop 4
    s_lshr_b32 s7, vcc_lo, 16
    s_and_b32 s46, s7, vcc_lo
    s_andn2_b32 s7, s8, s46
    s_cbranch_scc0 L2_b3
    s_cmp_eq_u32 s9, 0
    s_cbranch_scc1 L2_b3
    s_sub_u32 s9, s9, 1
    s_sleep 2
    s_branch L2_w3
L2_w9:
    buffer_load_dword v238, v237, s[28:31], 0 offen sc1
    s_waitcnt vmcnt(0)
    v_cmp_eq_u32 vcc, s36, v238
    s_nop 4
    s_lshr_b32 s7, vcc_lo, 16
    s_and_b32 s46, s7, vcc_lo
    s_andn2_b32 s7, s8, s46
    s_cbranch_scc0 L2_b9
    s_cmp_eq_u32 s9, 0
    s_cbranch_scc1 L2_b9
    s_sub_u32 s9, s9, 1
    s_sleep 2
    s_branch L2_w9
L2_r0:
    s_mov_b32 exec_lo, 0
    s_brev_b32 exec_hi, 1
L2_p0:
    s_cmp_eq_u32 s9, 0
    s_cbranch_scc1 L2_q0
    s_sub_u32 s9, s9, 1
    s_sleep 1
    buffer_load_dwordx4 v[224:227], v150, s[28:31], s45 offen offset:3072 sc1
L2_k0:
    s_waitcnt vmcnt(0)
    v_xor_b32 v152, s46, v224
    v_bitop3_b32 v152, v225, s47, v152 bitop3:0xbe
    v_bitop3_b32 v152, v226, s48, v152 bitop3:0xbe
    v_bitop3_b32 v152, v227, s49, v152 bitop3:0xbe
    v_and_b32 v152, 0xff, v152
    v_cmp_ne_u32 vcc, 0, v152
    s_nop 4
    s_cbranch_vccnz L2_p0
    s_mov_b64 exec, -1
    buffer_load_dwordx4 v[160:163], v150, s[28:31], s44 offen offset:0 sc1
    buffer_load_dwordx4 v[164:167], v150, s[28:31], s44 offen offset:1024 sc1
    buffer_load_dwordx4 v[168:171], v150, s[28:31], s44 offen offset:2048 sc1
    buffer_load_dwordx4 v[172:175], v150, s[28:31], s44 offen offset:3072 sc1
    buffer_load_dwordx4 v[176:179], v150, s[28:31], s45 offen offset:0 sc1
    buffer_load_dwordx4 v[180:183], v150, s[28:31], s45 offen offset:1024 sc1
    buffer_load_dwordx4 v[184:187], v150, s[28:31], s45 offen offset:2048 sc1
    buffer_load_dwordx4 v[188:191], v150, s[28:31], s45 offen offset:3072 sc1
    s_waitcnt vmcnt(6)
    s_branch L2_c0
L2_q0:
    s_mov_b64 exec, -1
    s_branch L2_o0
L2_r1:
    s_mov_b32 exec_lo, 0
    s_brev_b32 exec_hi, 1
L2_p1:
    s_cmp_eq_u32 s9, 0
    s_cbranch_scc1 L2_q1
    s_sub_u32 s9, s9, 1
    s_sleep 1
    buffer_load_dwordx4 v[224:227], v150, s[28:31], s45 offen offset:3072 sc1
L2_k1:
    s_waitcnt vmcnt(0)
    v_xor_b32 v152, s46, v224
    v_bitop3_b32 v152, v225, s47, v152 bitop3:0xbe
    v_bitop3_b32 v152, v226, s48, v152 bitop3:0xbe
    v_bitop3_b32 v152, v227, s49, v152 bitop3:0xbe
    v_and_b32 v152, 0xff, v152
    v_cmp_ne_u32 vcc, 0, v152
    s_nop 4
    s_cbranch_vccnz L2_p1
    s_mov_b64 exec, -1
    buffer_load_dwordx4 v[168:171], v150, s[28:31], s44 offen offset:2048 sc1
    buffer_load_dwordx4 v[172:175], v150, s[28:31], s44 offen offset:3072 sc1
    buffer_load_dwordx4 v[176:179], v150, s[28:31], s45 offen offset:0 sc1
    buffer_load_dwordx4 v[180:183], v150, s[28:31], s45 offen offset:1024 sc1
    buffer_load_dwordx4 v[184:187], v150, s[28:31], s45 offen offset:2048 sc1
    buffer_load_dwordx4 v[188:191], v150, s[28:31], s45 offen offset:3072 sc1
    s_waitcnt vmcnt(4)
    s_branch L2_c1
L2_q1:
    s_mov_b64 exec, -1
    s_branch L2_o1
L2_r2:
    s_mov_b32 exec_lo, 0
    s_brev_b32 exec_hi, 1
L2_p2:
    s_cmp_eq_u32 s9, 0
    s_cbranch_scc1 L2_q2
    s_sub_u32 s9, s9, 1
    s_sleep 1
    buffer_load_dwordx4 v[224:227], v150, s[28:31], s45 offen offset:3072 sc1
L2_k2:
    s_waitcnt vmcnt(0)
    v_xor_b32 v152, s46, v224
    v_bitop3_b32 v152, v225, s47, v152 bitop3:0xbe
    v_bitop3_b32 v152, v226, s48, v152 bitop3:0xbe
    v_bitop3_b32 v152, v227, s49, v152 bitop3:0xbe
    v_and_b32 v152, 0xff, v152
    v_cmp_ne_u32 vcc, 0, v152
    s_nop 4
    s_cbranch_vccnz L2_p2
    s_mov_b64 exec, -1
    buffer_load_dwordx4 v[176:179], v150, s[28:31], s45 offen offset:0 sc1
    buffer_load_dwordx4 v[180:183], v150, s[28:31], s45 offen offset:1024 sc1
    buffer_load_dwordx4 v[184:187], v150, s[28:31], s45 offen offset:2048 sc1
    buffer_load_dwordx4 v[188:191], v150, s[28:31], s45 offen offset:3072 sc1
    s_waitcnt vmcnt(2)
    s_branch L2_c2
L2_q2:
    s_mov_b64 exec, -1
    s_branch L2_o2
L2_r3:
    s_mov_b32 exec_lo, 0
    s_brev_b32 exec_hi, 1
L2_p3:
    s_cmp_eq_u32 s9, 0
    s_cbranch_scc1 L2_q3
    s_sub_u32 s9, s9, 1
    s_sleep 1
    buffer_load_dwordx4 v[224:227], v150, s[28:31], s45 offen offset:3072 sc1
L2_k3:
    s_waitcnt vmcnt(0)
    v_xor_b32 v152, s46, v224
    v_bitop3_b32 v152, v225, s47, v152 bitop3:0xbe
    v_bitop3_b32 v152, v226, s48, v152 bitop3:0xbe
    v_bitop3_b32 v152, v227, s49, v152 bitop3:0xbe
    v_and_b32 v152, 0xff, v152
    v_cmp_ne_u32 vcc, 0, v152
    s_nop 4
    s_cbranch_vccnz L2_p3
    s_mov_b64 exec, -1
    buffer_load_dwordx4 v[184:187], v150, s[28:31], s45 offen offset:2048 sc1
    buffer_load_dwordx4 v[188:191], v150, s[28:31], s45 offen offset:3072 sc1
    s_waitcnt vmcnt(0)
    s_branch L2_c3
L2_q3:
    s_mov_b64 exec, -1
    s_branch L2_o3
L2_fin:
L_end:
    s_endpgm
.org standalone__glu_gated_swiglu__prompt_kernel + 36864, 0
.section .rodata,"a"
.p2align 6
.amdhsa_kernel standalone__glu_gated_swiglu__prompt_kernel
  .amdhsa_next_free_vgpr 412
  .amdhsa_next_free_sgpr 64
  .amdhsa_accum_offset 256
  .amdhsa_group_segment_fixed_size 0
  .amdhsa_kernarg_size 56
  .amdhsa_user_sgpr_count 2
  .amdhsa_user_sgpr_kernarg_segment_ptr 1
  .amdhsa_system_sgpr_workgroup_id_x 1
.end_amdhsa_kernel
```
